```python
import torch

def _softmax(x, axis=-1):
    return torch.softmax(x, dim=axis)
def _gelu(x):
    return torch.nn.functional.gelu(x, approximate="tanh")
def _silu(x):
    return torch.nn.functional.silu(x)
def _sigmoid(x):
    return torch.sigmoid(x)
def _layernorm(x, axis=-1, eps=1e-5):
    m = x.mean(dim=axis, keepdim=True)
    v = x.var(dim=axis, keepdim=True, unbiased=False)
    return (x - m) / torch.sqrt(v + eps)
def _scatter_add(tgt, idx, src, axis=0):
    return tgt.clone().index_add_(axis, idx, src)
def _segment_sum(src, seg, n):
    out = torch.zeros((n,) + src.shape[1:], dtype=src.dtype)
    return out.index_add_(0, seg, src)
def _pad(x, pw):
    flat = tuple(v for pair in reversed(pw) for v in pair)
    return torch.nn.functional.pad(x, flat)

kernel_name = 'concat_heads__mha_block_cached__gqa_block_cached__near_ridge'

def setup_inputs():

    _w = (lambda a: (lambda t: t.to(torch.bfloat16) if t.is_floating_point() else t)(torch.as_tensor(a)))
    def _A_setup():
        B, Sq, D = 16, 160, 512
        H, Sk, Dh = 32, 1024, 128
        return {
            "x": _w((lambda *s: torch.randn(*s, dtype=torch.bfloat16) * 0.8)(B, Sq, D)),
            "k_cache": _w((lambda *s: torch.randn(*s, dtype=torch.bfloat16) * 0.8)(B, H, Sk, Dh)),
            "v_cache": _w((lambda *s: torch.randn(*s, dtype=torch.bfloat16) * 0.05)(B, H, Sk, Dh)),
            "wq": _w((lambda *s: torch.randn(*s, dtype=torch.bfloat16) * 0.8)(D, H * Dh) * (D ** -0.5)),
            "wo": _w((lambda *s: torch.randn(*s, dtype=torch.bfloat16) * 0.05)(H * Dh, D) * ((H * Dh) ** -0.5)),
        }
    _A_in = _A_setup()

    def _B_setup():
        B, Sq, D = 16, 160, 512
        Hq, Hkv, Sk, Dh = 32, 32, 1024, 128
        assert Hq % Hkv == 0, (Hq, Hkv)
        return {
            "x": _w((lambda *s: torch.randn(*s, dtype=torch.bfloat16) * 0.8)(B, Sq, D)),
            "k_cache": _w((lambda *s: torch.randn(*s, dtype=torch.bfloat16) * 0.8)(B, Hkv, Sk, Dh)),
            "v_cache": _w((lambda *s: torch.randn(*s, dtype=torch.bfloat16) * 0.05)(B, Hkv, Sk, Dh)),
            "wq": _w((lambda *s: torch.randn(*s, dtype=torch.bfloat16) * 0.8)(D, Hq * Dh) * (D ** -0.5)),
            "wo": _w((lambda *s: torch.randn(*s, dtype=torch.bfloat16) * 0.05)(Hq * Dh, D) * ((Hq * Dh) ** -0.5)),
        }
    _B_in = _B_setup()

    return {
        "A_x": _A_in["x"],
        "A_k_cache": _A_in["k_cache"],
        "A_v_cache": _A_in["v_cache"],
        "A_wq": _A_in["wq"],
        "A_wo": _A_in["wo"],
        "B_x": _B_in["x"],
        "B_k_cache": _B_in["k_cache"],
        "B_v_cache": _B_in["v_cache"],
        "B_wq": _B_in["wq"],
        "B_wo": _B_in["wo"],
    }

def reference(A_x, A_k_cache, A_v_cache, A_wq, A_wo, B_x, B_k_cache, B_v_cache, B_wq, B_wo):
    def _A_ref(x, k_cache, v_cache, wq, wo):
        B, Sq, D = x.shape
        H, Dh = 32, 128
        q = (lambda x, *d: x.permute(*d))((x @ wq).reshape(B, Sq, H, Dh), 0, 2, 1, 3)
        scores = torch.einsum("bhqd,bhkd->bhqk", q, k_cache) * (Dh ** -0.5)
        p = _softmax(scores, axis=-1)
        o = torch.einsum("bhqk,bhkd->bhqd", p, v_cache)
        return (lambda x, *d: x.permute(*d))(o, 0, 2, 1, 3).reshape(B, Sq, H * Dh) @ wo

    def _B_ref(x, k_cache, v_cache, wq, wo):
        B, Sq, D = x.shape
        Hq, Dh = 32, 128
        Hkv = k_cache.shape[1]
        rep = Hq // Hkv
        q = (lambda x, *d: x.permute(*d))((x @ wq).reshape(B, Sq, Hq, Dh), 0, 2, 1, 3)
        k = (lambda x, n, axis: torch.repeat_interleave(x, n, dim=axis))(k_cache, rep, axis=1)
        v = (lambda x, n, axis: torch.repeat_interleave(x, n, dim=axis))(v_cache, rep, axis=1)
        scores = torch.einsum("bhqd,bhkd->bhqk", q, k) * (Dh ** -0.5)
        p = _softmax(scores, axis=-1)
        o = torch.einsum("bhqk,bhkd->bhqd", p, v)
        return (lambda x, *d: x.permute(*d))(o, 0, 2, 1, 3).reshape(B, Sq, Hq * Dh) @ wo

    a = _A_ref(A_x, A_k_cache, A_v_cache, A_wq, A_wo)
    b = _B_ref(B_x, B_k_cache, B_v_cache, B_wq, B_wo)
    return torch.concatenate([a, b], axis=-1)
```

```asm
; @launch kernel=repack_kernel grid=(160,1,1) block=(256,1,1) lds=0
; @launch kernel=attn_kernel grid=(256,1,1) block=(640,1,1) lds=163840
; @launch kernel=oproj_kernel grid=(256,1,1) block=(640,1,1) lds=98304
.amdgcn_target "amdgcn-amd-amdhsa--gfx950"
.text
.globl attn_kernel
.p2align 8
.type attn_kernel,@function
attn_kernel:
    s_cmp_ge_u32 s2, 256
    s_cbranch_scc1 attn_end
    s_load_dwordx16 s[40:55], s[0:1], 0
    s_load_dwordx4 s[56:59], s[0:1], 64
    s_load_dwordx2 s[60:61], s[0:1], 96
    v_lshrrev_b32 v1, 6, v0
    v_and_b32 v10, 63, v0
    s_nop 0
    v_readfirstlane_b32 s4, v1
    s_nop 3
    s_mov_b32 s38, s2
    s_mov_b32 s39, s4
    s_cmp_ge_u32 s4, 5
    s_cselect_b32 s34, 1, 0
    s_and_b32 s5, s2, 15
    s_lshr_b32 s6, s2, 4
    s_lshl_b32 s6, s6, 1
    s_add_u32 s6, s6, s34
    s_mul_i32 s7, s34, 5
    s_sub_u32 s4, s4, s7
    s_mul_i32 s35, s34, 81920
    s_lshl_b32 s24, s4, 12
    s_add_u32 s24, s24, s35
    s_lshl_b32 s30, s4, 17
    s_and_b32 s31, s4, 1
    s_lshl_b32 s31, s31, 12
    s_lshr_b32 s33, s6, 1
    s_xor_b32 s33, s33, s5
    s_lshl_b32 s33, s33, 1
    s_add_u32 s33, s33, s34
    s_and_b32 s33, s33, 31
    s_lshl_b32 s33, s33, 13
    s_add_u32 s33, s33, s31
    s_mov_b32 s28, 0x3e0293ee
    s_mov_b32 s29, 0x41000000
    s_mov_b32 s37, 0x3f803f80
    s_mov_b32 s36, 0
    v_lshrrev_b32 v16, 4, v10
    v_and_b32 v17, 15, v10
    v_lshlrev_b32 v18, 1, v16
    v_xor_b32 v18, v17, v18
    v_lshlrev_b32 v18, 4, v18
    v_lshl_add_u32 v0, v16, 13, v18
    v_lshl_add_u32 v19, v16, 8, v18
    v_xor_b32 v20, v17, v16
    s_cmp_lt_u32 s4, 2
    s_cselect_b64 vcc, -1, 0
    v_xor_b32 v21, 0, v20
    v_lshlrev_b32 v21, 4, v21
    v_lshl_add_u32 v21, v16, 8, v21
    v_cndmask_b32 v1, v19, v21, vcc
    v_xor_b32 v21, 4, v20
    v_lshlrev_b32 v21, 4, v21
    v_lshl_add_u32 v21, v16, 8, v21
    v_cndmask_b32 v2, v19, v21, vcc
    v_xor_b32 v21, 8, v20
    v_lshlrev_b32 v21, 4, v21
    v_lshl_add_u32 v21, v16, 8, v21
    v_cndmask_b32 v3, v19, v21, vcc
    v_xor_b32 v21, 12, v20
    v_lshlrev_b32 v21, 4, v21
    v_lshl_add_u32 v21, v16, 8, v21
    v_cndmask_b32 v4, v19, v21, vcc
    v_and_b32 v16, 31, v10
    v_lshrrev_b32 v17, 5, v10
    v_and_b32 v18, 15, v16
    v_lshlrev_b32 v19, 3, v17
    v_xor_b32 v18, v18, v19
    v_lshlrev_b32 v18, 4, v18
    v_lshl_add_u32 v9, v16, 8, v18
    v_add_u32 v9, s35, v9
    v_bfe_u32 v18, v10, 2, 2
    v_and_b32 v19, 3, v10
    v_bfe_u32 v20, v10, 4, 1
    v_and_b32 v21, 1, v19
    v_lshlrev_b32 v21, 7, v21
    v_lshl_add_u32 v21, v20, 4, v21
    v_lshrrev_b32 v22, 1, v19
    v_lshl_add_u32 v21, v22, 3, v21
    v_lshl_add_u32 v21, v18, 8, v21
    v_lshl_add_u32 v21, v17, 13, v21
    v_add_u32 v21, s35, v21
    v_add_u32 v21, 32768, v21
    v_xor_b32 v22, 0, v18
    v_lshl_add_u32 v5, v22, 5, v21
    v_xor_b32 v22, 1, v18
    v_lshl_add_u32 v6, v22, 5, v21
    v_xor_b32 v22, 2, v18
    v_lshl_add_u32 v7, v22, 5, v21
    v_xor_b32 v22, 3, v18
    v_lshl_add_u32 v8, v22, 5, v21
    v_mul_u32_u24 v12, 7168, v17
    v_add_u32 v12, 32768, v12
    s_waitcnt lgkmcnt(0)
    s_lshl_b32 s7, s6, 8
    s_add_u32 s12, s46, s7
    s_addc_u32 s13, s47, 0
    s_sub_u32 s14, 4194304, s7
    s_mov_b32 s15, 0x00020000
    s_add_u32 s72, s56, s7
    s_addc_u32 s73, s57, 0
    s_sub_u32 s74, 4194304, s7
    s_mov_b32 s75, 0x00020000
    s_cmp_gt_u32 s4, 3
    s_cbranch_scc1 nodma_1
    s_add_u32 m0, s24, 32768
    s_add_u32 s25, s30, 0
    buffer_load_dwordx4 v0, s[12:15], s25 offen offset:0 lds
    s_add_u32 s25, s25, 31744
    buffer_load_dwordx4 v0, s[12:15], s25 offen offset:1024 lds
    s_add_u32 s25, s25, 31744
    buffer_load_dwordx4 v0, s[12:15], s25 offen offset:2048 lds
    s_add_u32 s25, s25, 31744
    buffer_load_dwordx4 v0, s[12:15], s25 offen offset:3072 lds
nodma_1:
    s_cmp_gt_u32 s4, 3
    s_cbranch_scc1 nodma_2
    s_add_u32 m0, s24, 49152
    s_add_u32 s25, s30, 524288
    buffer_load_dwordx4 v0, s[12:15], s25 offen offset:0 lds
    s_add_u32 s25, s25, 31744
    buffer_load_dwordx4 v0, s[12:15], s25 offen offset:1024 lds
    s_add_u32 s25, s25, 31744
    buffer_load_dwordx4 v0, s[12:15], s25 offen offset:2048 lds
    s_add_u32 s25, s25, 31744
    buffer_load_dwordx4 v0, s[12:15], s25 offen offset:3072 lds
nodma_2:
    s_cmp_gt_u32 s4, 3
    s_cbranch_scc1 nodma_3
    s_add_u32 m0, s24, 65536
    s_add_u32 s25, s30, 1048576
    buffer_load_dwordx4 v0, s[12:15], s25 offen offset:0 lds
    s_add_u32 s25, s25, 31744
    buffer_load_dwordx4 v0, s[12:15], s25 offen offset:1024 lds
    s_add_u32 s25, s25, 31744
    buffer_load_dwordx4 v0, s[12:15], s25 offen offset:2048 lds
    s_add_u32 s25, s25, 31744
    buffer_load_dwordx4 v0, s[12:15], s25 offen offset:3072 lds
nodma_3:
    s_cmp_gt_u32 s4, 3
    s_cbranch_scc1 nodma_4
    s_add_u32 m0, s24, 0
    s_add_u32 s25, s30, 1572864
    buffer_load_dwordx4 v0, s[12:15], s25 offen offset:0 lds
    s_add_u32 s25, s25, 31744
    buffer_load_dwordx4 v0, s[12:15], s25 offen offset:1024 lds
    s_add_u32 s25, s25, 31744
    buffer_load_dwordx4 v0, s[12:15], s25 offen offset:2048 lds
    s_add_u32 s25, s25, 31744
    buffer_load_dwordx4 v0, s[12:15], s25 offen offset:3072 lds
nodma_4:
    s_cmp_gt_u32 s4, 3
    s_cbranch_scc1 nodma_5
    s_add_u32 m0, s24, 16384
    s_add_u32 s25, s30, 2097152
    buffer_load_dwordx4 v0, s[12:15], s25 offen offset:0 lds
    s_add_u32 s25, s25, 31744
    buffer_load_dwordx4 v0, s[12:15], s25 offen offset:1024 lds
    s_add_u32 s25, s25, 31744
    buffer_load_dwordx4 v0, s[12:15], s25 offen offset:2048 lds
    s_add_u32 s25, s25, 31744
    buffer_load_dwordx4 v0, s[12:15], s25 offen offset:3072 lds
nodma_5:
    s_mov_b32 s66, 4194304
    s_mov_b32 s67, 0x00020000
    s_lshl_b32 s76, s38, 14
    s_min_u32 s77, s39, 7
    s_lshl_b32 s77, s77, 11
    s_add_u32 s76, s76, s77
    v_lshlrev_b32 v32, 4, v10
    s_mov_b64 s[64:65], s[48:49]
    buffer_load_dwordx4 v[16:19], v32, s[64:67], s76 offen
    buffer_load_dwordx4 v[20:23], v32, s[64:67], s76 offen offset:1024
    s_mov_b64 s[64:65], s[58:59]
    buffer_load_dwordx4 v[24:27], v32, s[64:67], s76 offen
    buffer_load_dwordx4 v[28:31], v32, s[64:67], s76 offen offset:1024
task_loop:
    s_cmp_eq_u32 s36, 0
    s_cselect_b64 s[66:67], s[42:43], s[52:53]
    s_cselect_b64 s[68:69], s[44:45], s[54:55]
    s_cmp_lt_u32 s4, 2
    s_cselect_b64 s[66:67], s[66:67], s[68:69]
    s_lshl_b32 s3, s36, 4
    s_add_u32 s3, s3, s5
    s_mul_i32 s7, s3, 5
    s_add_u32 s7, s7, s4
    s_lshl_b32 s7, s7, 15
    s_add_u32 s7, s7, 41943040
    s_add_u32 s8, s60, s7
    s_addc_u32 s9, s61, 0
    s_mov_b32 s10, 32768
    s_mov_b32 s11, 0x00020000
    s_lshl_b32 s7, s5, 5
    s_add_u32 s7, s7, s6
    s_lshl_b32 s7, s7, 18
    s_add_u32 s16, s66, s7
    s_addc_u32 s17, s67, 0
    s_mov_b32 s18, 262144
    s_mov_b32 s19, 0x00020000
    s_mul_i32 s7, s3, 1310720
    s_lshl_b32 s34, s6, 13
    s_add_u32 s7, s7, s34
    s_add_u32 s20, s60, s7
    s_addc_u32 s21, s61, 0
    s_sub_u32 s22, 1310720, s34
    s_mov_b32 s23, 0x00020000
    v_lshlrev_b32 v14, 4, v10
    s_mov_b32 s78, 0
    buffer_load_dwordx4 v[40:43], v14, s[8:11], s78 offen offset:0
    buffer_load_dwordx4 v[44:47], v14, s[8:11], s78 offen offset:1024
    buffer_load_dwordx4 v[48:51], v14, s[8:11], s78 offen offset:2048
    buffer_load_dwordx4 v[52:55], v14, s[8:11], s78 offen offset:3072
    s_mov_b32 s78, 4096
    buffer_load_dwordx4 v[56:59], v14, s[8:11], s78 offen offset:0
    buffer_load_dwordx4 v[60:63], v14, s[8:11], s78 offen offset:1024
    buffer_load_dwordx4 v[64:67], v14, s[8:11], s78 offen offset:2048
    buffer_load_dwordx4 v[68:71], v14, s[8:11], s78 offen offset:3072
    s_mov_b32 s78, 8192
    buffer_load_dwordx4 v[72:75], v14, s[8:11], s78 offen offset:0
    buffer_load_dwordx4 v[76:79], v14, s[8:11], s78 offen offset:1024
    buffer_load_dwordx4 v[80:83], v14, s[8:11], s78 offen offset:2048
    buffer_load_dwordx4 v[84:87], v14, s[8:11], s78 offen offset:3072
    v_mov_b32 v104, 0
    v_mov_b32 v105, 0
    v_mov_b32 v106, 0
    v_mov_b32 v107, 0
    v_mov_b32 v108, 0
    v_mov_b32 v109, 0
    v_mov_b32 v110, 0
    v_mov_b32 v111, 0
    v_mov_b32 v112, 0
    v_mov_b32 v113, 0
    v_mov_b32 v114, 0
    v_mov_b32 v115, 0
    v_mov_b32 v116, 0
    v_mov_b32 v117, 0
    v_mov_b32 v118, 0
    v_mov_b32 v119, 0
    v_mov_b32 v120, 0
    v_mov_b32 v121, 0
    v_mov_b32 v122, 0
    v_mov_b32 v123, 0
    v_mov_b32 v124, 0
    v_mov_b32 v125, 0
    v_mov_b32 v126, 0
    v_mov_b32 v127, 0
    v_mov_b32 v128, 0
    v_mov_b32 v129, 0
    v_mov_b32 v130, 0
    v_mov_b32 v131, 0
    v_mov_b32 v132, 0
    v_mov_b32 v133, 0
    v_mov_b32 v134, 0
    v_mov_b32 v135, 0
    v_mov_b32 v136, 0
    v_mov_b32 v137, 0
    v_mov_b32 v138, 0
    v_mov_b32 v139, 0
    v_mov_b32 v140, 0
    v_mov_b32 v141, 0
    v_mov_b32 v142, 0
    v_mov_b32 v143, 0
    v_mov_b32 v144, 0
    v_mov_b32 v145, 0
    v_mov_b32 v146, 0
    v_mov_b32 v147, 0
    v_mov_b32 v148, 0
    v_mov_b32 v149, 0
    v_mov_b32 v150, 0
    v_mov_b32 v151, 0
    v_mov_b32 v152, 0
    v_mov_b32 v153, 0
    v_mov_b32 v154, 0
    v_mov_b32 v155, 0
    v_mov_b32 v156, 0
    v_mov_b32 v157, 0
    v_mov_b32 v158, 0
    v_mov_b32 v159, 0
    v_mov_b32 v160, 0
    v_mov_b32 v161, 0
    v_mov_b32 v162, 0
    v_mov_b32 v163, 0
    v_mov_b32 v164, 0
    v_mov_b32 v165, 0
    v_mov_b32 v166, 0
    v_mov_b32 v167, 0
    s_waitcnt vmcnt(8)
    s_barrier
    ds_read_b64_tr_b16 v[16:17], v5 offset:0
    ds_read_b64_tr_b16 v[18:19], v5 offset:1024
    ds_read_b64_tr_b16 v[20:21], v6 offset:0
    ds_read_b64_tr_b16 v[22:23], v6 offset:1024
    ds_read_b64_tr_b16 v[24:25], v7 offset:0
    ds_read_b64_tr_b16 v[26:27], v7 offset:1024
    ds_read_b64_tr_b16 v[28:29], v8 offset:0
    ds_read_b64_tr_b16 v[30:31], v8 offset:1024
    ds_read_b64_tr_b16 v[32:33], v5 offset:2048
    ds_read_b64_tr_b16 v[34:35], v5 offset:3072
    ds_read_b64_tr_b16 v[36:37], v6 offset:2048
    ds_read_b64_tr_b16 v[38:39], v6 offset:3072
    s_waitcnt lgkmcnt(10)
    v_mfma_f32_32x32x16_bf16 v[104:119], v[16:19], v[40:43], v[104:119]
    ds_read_b64_tr_b16 v[16:17], v7 offset:2048
    ds_read_b64_tr_b16 v[18:19], v7 offset:3072
    s_waitcnt lgkmcnt(10)
    v_mfma_f32_32x32x16_bf16 v[120:135], v[20:23], v[40:43], v[120:135]
    ds_read_b64_tr_b16 v[20:21], v8 offset:2048
    ds_read_b64_tr_b16 v[22:23], v8 offset:3072
    s_waitcnt lgkmcnt(10)
    v_mfma_f32_32x32x16_bf16 v[136:151], v[24:27], v[40:43], v[136:151]
    ds_read_b64_tr_b16 v[24:25], v5 offset:4096
    ds_read_b64_tr_b16 v[26:27], v5 offset:5120
    s_waitcnt lgkmcnt(10)
    v_mfma_f32_32x32x16_bf16 v[152:167], v[28:31], v[40:43], v[152:167]
    ds_read_b64_tr_b16 v[28:29], v6 offset:4096
    ds_read_b64_tr_b16 v[30:31], v6 offset:5120
    s_waitcnt lgkmcnt(10)
    v_mfma_f32_32x32x16_bf16 v[104:119], v[32:35], v[44:47], v[104:119]
    ds_read_b64_tr_b16 v[32:33], v7 offset:4096
    ds_read_b64_tr_b16 v[34:35], v7 offset:5120
    s_waitcnt lgkmcnt(10)
    v_mfma_f32_32x32x16_bf16 v[120:135], v[36:39], v[44:47], v[120:135]
    ds_read_b64_tr_b16 v[36:37], v8 offset:4096
    ds_read_b64_tr_b16 v[38:39], v8 offset:5120
    s_waitcnt lgkmcnt(10)
    v_mfma_f32_32x32x16_bf16 v[136:151], v[16:19], v[44:47], v[136:151]
    ds_read_b64_tr_b16 v[16:17], v5 offset:6144
    ds_read_b64_tr_b16 v[18:19], v5 offset:7168
    s_waitcnt lgkmcnt(10)
    v_mfma_f32_32x32x16_bf16 v[152:167], v[20:23], v[44:47], v[152:167]
    ds_read_b64_tr_b16 v[20:21], v6 offset:6144
    ds_read_b64_tr_b16 v[22:23], v6 offset:7168
    s_waitcnt lgkmcnt(10)
    v_mfma_f32_32x32x16_bf16 v[104:119], v[24:27], v[48:51], v[104:119]
    ds_read_b64_tr_b16 v[24:25], v7 offset:6144
    ds_read_b64_tr_b16 v[26:27], v7 offset:7168
    s_waitcnt lgkmcnt(10)
    v_mfma_f32_32x32x16_bf16 v[120:135], v[28:31], v[48:51], v[120:135]
    ds_read_b64_tr_b16 v[28:29], v8 offset:6144
    ds_read_b64_tr_b16 v[30:31], v8 offset:7168
    s_waitcnt lgkmcnt(10)
    v_mfma_f32_32x32x16_bf16 v[136:151], v[32:35], v[48:51], v[136:151]
    s_waitcnt lgkmcnt(8)
    v_mfma_f32_32x32x16_bf16 v[152:167], v[36:39], v[48:51], v[152:167]
    s_waitcnt lgkmcnt(6)
    v_mfma_f32_32x32x16_bf16 v[104:119], v[16:19], v[52:55], v[104:119]
    s_waitcnt lgkmcnt(4)
    v_mfma_f32_32x32x16_bf16 v[120:135], v[20:23], v[52:55], v[120:135]
    s_waitcnt lgkmcnt(2)
    v_mfma_f32_32x32x16_bf16 v[136:151], v[24:27], v[52:55], v[136:151]
    s_waitcnt lgkmcnt(0)
    v_mfma_f32_32x32x16_bf16 v[152:167], v[28:31], v[52:55], v[152:167]
    s_mov_b32 s78, 12288
    buffer_load_dwordx4 v[40:43], v14, s[8:11], s78 offen offset:0
    buffer_load_dwordx4 v[44:47], v14, s[8:11], s78 offen offset:1024
    buffer_load_dwordx4 v[48:51], v14, s[8:11], s78 offen offset:2048
    buffer_load_dwordx4 v[52:55], v14, s[8:11], s78 offen offset:3072
    s_waitcnt vmcnt(8)
    s_barrier
    s_cmp_gt_u32 s4, 3
    s_cbranch_scc1 nodma_6
    s_add_u32 m0, s24, 32768
    s_add_u32 s25, s30, 2621440
    buffer_load_dwordx4 v0, s[12:15], s25 offen offset:0 lds
    s_add_u32 s25, s25, 31744
    buffer_load_dwordx4 v0, s[12:15], s25 offen offset:1024 lds
    s_add_u32 s25, s25, 31744
    buffer_load_dwordx4 v0, s[12:15], s25 offen offset:2048 lds
    s_add_u32 s25, s25, 31744
    buffer_load_dwordx4 v0, s[12:15], s25 offen offset:3072 lds
nodma_6:
    ds_read_b64_tr_b16 v[16:17], v5 offset:16384
    ds_read_b64_tr_b16 v[18:19], v5 offset:17408
    ds_read_b64_tr_b16 v[20:21], v6 offset:16384
    ds_read_b64_tr_b16 v[22:23], v6 offset:17408
    ds_read_b64_tr_b16 v[24:25], v7 offset:16384
    ds_read_b64_tr_b16 v[26:27], v7 offset:17408
    ds_read_b64_tr_b16 v[28:29], v8 offset:16384
    ds_read_b64_tr_b16 v[30:31], v8 offset:17408
    ds_read_b64_tr_b16 v[32:33], v5 offset:18432
    ds_read_b64_tr_b16 v[34:35], v5 offset:19456
    ds_read_b64_tr_b16 v[36:37], v6 offset:18432
    ds_read_b64_tr_b16 v[38:39], v6 offset:19456
    s_waitcnt lgkmcnt(10)
    v_mfma_f32_32x32x16_bf16 v[104:119], v[16:19], v[56:59], v[104:119]
    ds_read_b64_tr_b16 v[16:17], v7 offset:18432
    ds_read_b64_tr_b16 v[18:19], v7 offset:19456
    s_waitcnt lgkmcnt(10)
    v_mfma_f32_32x32x16_bf16 v[120:135], v[20:23], v[56:59], v[120:135]
    ds_read_b64_tr_b16 v[20:21], v8 offset:18432
    ds_read_b64_tr_b16 v[22:23], v8 offset:19456
    s_waitcnt lgkmcnt(10)
    v_mfma_f32_32x32x16_bf16 v[136:151], v[24:27], v[56:59], v[136:151]
    ds_read_b64_tr_b16 v[24:25], v5 offset:20480
    ds_read_b64_tr_b16 v[26:27], v5 offset:21504
    s_waitcnt lgkmcnt(10)
    v_mfma_f32_32x32x16_bf16 v[152:167], v[28:31], v[56:59], v[152:167]
    ds_read_b64_tr_b16 v[28:29], v6 offset:20480
    ds_read_b64_tr_b16 v[30:31], v6 offset:21504
    s_waitcnt lgkmcnt(10)
    v_mfma_f32_32x32x16_bf16 v[104:119], v[32:35], v[60:63], v[104:119]
    ds_read_b64_tr_b16 v[32:33], v7 offset:20480
    ds_read_b64_tr_b16 v[34:35], v7 offset:21504
    s_waitcnt lgkmcnt(10)
    v_mfma_f32_32x32x16_bf16 v[120:135], v[36:39], v[60:63], v[120:135]
    ds_read_b64_tr_b16 v[36:37], v8 offset:20480
    ds_read_b64_tr_b16 v[38:39], v8 offset:21504
    s_waitcnt lgkmcnt(10)
    v_mfma_f32_32x32x16_bf16 v[136:151], v[16:19], v[60:63], v[136:151]
    ds_read_b64_tr_b16 v[16:17], v5 offset:22528
    ds_read_b64_tr_b16 v[18:19], v5 offset:23552
    s_waitcnt lgkmcnt(10)
    v_mfma_f32_32x32x16_bf16 v[152:167], v[20:23], v[60:63], v[152:167]
    ds_read_b64_tr_b16 v[20:21], v6 offset:22528
    ds_read_b64_tr_b16 v[22:23], v6 offset:23552
    s_waitcnt lgkmcnt(10)
    v_mfma_f32_32x32x16_bf16 v[104:119], v[24:27], v[64:67], v[104:119]
    ds_read_b64_tr_b16 v[24:25], v7 offset:22528
    ds_read_b64_tr_b16 v[26:27], v7 offset:23552
    s_waitcnt lgkmcnt(10)
    v_mfma_f32_32x32x16_bf16 v[120:135], v[28:31], v[64:67], v[120:135]
    ds_read_b64_tr_b16 v[28:29], v8 offset:22528
    ds_read_b64_tr_b16 v[30:31], v8 offset:23552
    s_waitcnt lgkmcnt(10)
    v_mfma_f32_32x32x16_bf16 v[136:151], v[32:35], v[64:67], v[136:151]
    s_waitcnt lgkmcnt(8)
    v_mfma_f32_32x32x16_bf16 v[152:167], v[36:39], v[64:67], v[152:167]
    s_waitcnt lgkmcnt(6)
    v_mfma_f32_32x32x16_bf16 v[104:119], v[16:19], v[68:71], v[104:119]
    s_waitcnt lgkmcnt(4)
    v_mfma_f32_32x32x16_bf16 v[120:135], v[20:23], v[68:71], v[120:135]
    s_waitcnt lgkmcnt(2)
    v_mfma_f32_32x32x16_bf16 v[136:151], v[24:27], v[68:71], v[136:151]
    s_waitcnt lgkmcnt(0)
    v_mfma_f32_32x32x16_bf16 v[152:167], v[28:31], v[68:71], v[152:167]
    s_mov_b32 s78, 16384
    buffer_load_dwordx4 v[56:59], v14, s[8:11], s78 offen offset:0
    buffer_load_dwordx4 v[60:63], v14, s[8:11], s78 offen offset:1024
    buffer_load_dwordx4 v[64:67], v14, s[8:11], s78 offen offset:2048
    buffer_load_dwordx4 v[68:71], v14, s[8:11], s78 offen offset:3072
    s_cmp_gt_u32 s4, 3
    s_cbranch_scc1 wn_7
    s_waitcnt vmcnt(12)
    s_branch wj_8
wn_7:
    s_waitcnt vmcnt(8)
wj_8:
    s_barrier
    s_cmp_gt_u32 s4, 3
    s_cbranch_scc1 nodma_9
    s_add_u32 m0, s24, 49152
    s_add_u32 s25, s30, 3145728
    buffer_load_dwordx4 v0, s[12:15], s25 offen offset:0 lds
    s_add_u32 s25, s25, 31744
    buffer_load_dwordx4 v0, s[12:15], s25 offen offset:1024 lds
    s_add_u32 s25, s25, 31744
    buffer_load_dwordx4 v0, s[12:15], s25 offen offset:2048 lds
    s_add_u32 s25, s25, 31744
    buffer_load_dwordx4 v0, s[12:15], s25 offen offset:3072 lds
nodma_9:
    v_add_u32 v5, 0x8000, v5
    v_add_u32 v6, 0x8000, v6
    v_add_u32 v7, 0x8000, v7
    v_add_u32 v8, 0x8000, v8
    ds_read_b64_tr_b16 v[16:17], v5 offset:0
    ds_read_b64_tr_b16 v[18:19], v5 offset:1024
    ds_read_b64_tr_b16 v[20:21], v6 offset:0
    ds_read_b64_tr_b16 v[22:23], v6 offset:1024
    ds_read_b64_tr_b16 v[24:25], v7 offset:0
    ds_read_b64_tr_b16 v[26:27], v7 offset:1024
    ds_read_b64_tr_b16 v[28:29], v8 offset:0
    ds_read_b64_tr_b16 v[30:31], v8 offset:1024
    ds_read_b64_tr_b16 v[32:33], v5 offset:2048
    ds_read_b64_tr_b16 v[34:35], v5 offset:3072
    ds_read_b64_tr_b16 v[36:37], v6 offset:2048
    ds_read_b64_tr_b16 v[38:39], v6 offset:3072
    s_waitcnt lgkmcnt(10)
    v_mfma_f32_32x32x16_bf16 v[104:119], v[16:19], v[72:75], v[104:119]
    ds_read_b64_tr_b16 v[16:17], v7 offset:2048
    ds_read_b64_tr_b16 v[18:19], v7 offset:3072
    s_waitcnt lgkmcnt(10)
    v_mfma_f32_32x32x16_bf16 v[120:135], v[20:23], v[72:75], v[120:135]
    ds_read_b64_tr_b16 v[20:21], v8 offset:2048
    ds_read_b64_tr_b16 v[22:23], v8 offset:3072
    s_waitcnt lgkmcnt(10)
    v_mfma_f32_32x32x16_bf16 v[136:151], v[24:27], v[72:75], v[136:151]
    ds_read_b64_tr_b16 v[24:25], v5 offset:4096
    ds_read_b64_tr_b16 v[26:27], v5 offset:5120
    s_waitcnt lgkmcnt(10)
    v_mfma_f32_32x32x16_bf16 v[152:167], v[28:31], v[72:75], v[152:167]
    ds_read_b64_tr_b16 v[28:29], v6 offset:4096
    ds_read_b64_tr_b16 v[30:31], v6 offset:5120
    s_waitcnt lgkmcnt(10)
    v_mfma_f32_32x32x16_bf16 v[104:119], v[32:35], v[76:79], v[104:119]
    ds_read_b64_tr_b16 v[32:33], v7 offset:4096
    ds_read_b64_tr_b16 v[34:35], v7 offset:5120
    s_waitcnt lgkmcnt(10)
    v_mfma_f32_32x32x16_bf16 v[120:135], v[36:39], v[76:79], v[120:135]
    ds_read_b64_tr_b16 v[36:37], v8 offset:4096
    ds_read_b64_tr_b16 v[38:39], v8 offset:5120
    s_waitcnt lgkmcnt(10)
    v_mfma_f32_32x32x16_bf16 v[136:151], v[16:19], v[76:79], v[136:151]
    ds_read_b64_tr_b16 v[16:17], v5 offset:6144
    ds_read_b64_tr_b16 v[18:19], v5 offset:7168
    s_waitcnt lgkmcnt(10)
    v_mfma_f32_32x32x16_bf16 v[152:167], v[20:23], v[76:79], v[152:167]
    ds_read_b64_tr_b16 v[20:21], v6 offset:6144
    ds_read_b64_tr_b16 v[22:23], v6 offset:7168
    s_waitcnt lgkmcnt(10)
    v_mfma_f32_32x32x16_bf16 v[104:119], v[24:27], v[80:83], v[104:119]
    ds_read_b64_tr_b16 v[24:25], v7 offset:6144
    ds_read_b64_tr_b16 v[26:27], v7 offset:7168
    s_waitcnt lgkmcnt(10)
    v_mfma_f32_32x32x16_bf16 v[120:135], v[28:31], v[80:83], v[120:135]
    ds_read_b64_tr_b16 v[28:29], v8 offset:6144
    ds_read_b64_tr_b16 v[30:31], v8 offset:7168
    s_waitcnt lgkmcnt(10)
    v_mfma_f32_32x32x16_bf16 v[136:151], v[32:35], v[80:83], v[136:151]
    s_waitcnt lgkmcnt(8)
    v_mfma_f32_32x32x16_bf16 v[152:167], v[36:39], v[80:83], v[152:167]
    s_waitcnt lgkmcnt(6)
    v_mfma_f32_32x32x16_bf16 v[104:119], v[16:19], v[84:87], v[104:119]
    s_waitcnt lgkmcnt(4)
    v_mfma_f32_32x32x16_bf16 v[120:135], v[20:23], v[84:87], v[120:135]
    s_waitcnt lgkmcnt(2)
    v_mfma_f32_32x32x16_bf16 v[136:151], v[24:27], v[84:87], v[136:151]
    s_waitcnt lgkmcnt(0)
    v_mfma_f32_32x32x16_bf16 v[152:167], v[28:31], v[84:87], v[152:167]
    v_subrev_u32 v5, 0x8000, v5
    v_subrev_u32 v6, 0x8000, v6
    v_subrev_u32 v7, 0x8000, v7
    v_subrev_u32 v8, 0x8000, v8
    s_mov_b32 s78, 20480
    buffer_load_dwordx4 v[72:75], v14, s[8:11], s78 offen offset:0
    buffer_load_dwordx4 v[76:79], v14, s[8:11], s78 offen offset:1024
    buffer_load_dwordx4 v[80:83], v14, s[8:11], s78 offen offset:2048
    buffer_load_dwordx4 v[84:87], v14, s[8:11], s78 offen offset:3072
    s_cmp_gt_u32 s4, 3
    s_cbranch_scc1 wn_10
    s_waitcnt vmcnt(16)
    s_branch wj_11
wn_10:
    s_waitcnt vmcnt(8)
wj_11:
    s_barrier
    s_cmp_gt_u32 s4, 3
    s_cbranch_scc1 nodma_12
    s_add_u32 m0, s24, 65536
    s_add_u32 s25, s30, 3670016
    buffer_load_dwordx4 v0, s[12:15], s25 offen offset:0 lds
    s_add_u32 s25, s25, 31744
    buffer_load_dwordx4 v0, s[12:15], s25 offen offset:1024 lds
    s_add_u32 s25, s25, 31744
    buffer_load_dwordx4 v0, s[12:15], s25 offen offset:2048 lds
    s_add_u32 s25, s25, 31744
    buffer_load_dwordx4 v0, s[12:15], s25 offen offset:3072 lds
nodma_12:
    v_subrev_u32 v5, 0x8000, v5
    v_subrev_u32 v6, 0x8000, v6
    v_subrev_u32 v7, 0x8000, v7
    v_subrev_u32 v8, 0x8000, v8
    ds_read_b64_tr_b16 v[16:17], v5 offset:0
    ds_read_b64_tr_b16 v[18:19], v5 offset:1024
    ds_read_b64_tr_b16 v[20:21], v6 offset:0
    ds_read_b64_tr_b16 v[22:23], v6 offset:1024
    ds_read_b64_tr_b16 v[24:25], v7 offset:0
    ds_read_b64_tr_b16 v[26:27], v7 offset:1024
    ds_read_b64_tr_b16 v[28:29], v8 offset:0
    ds_read_b64_tr_b16 v[30:31], v8 offset:1024
    ds_read_b64_tr_b16 v[32:33], v5 offset:2048
    ds_read_b64_tr_b16 v[34:35], v5 offset:3072
    ds_read_b64_tr_b16 v[36:37], v6 offset:2048
    ds_read_b64_tr_b16 v[38:39], v6 offset:3072
    s_waitcnt lgkmcnt(10)
    v_mfma_f32_32x32x16_bf16 v[104:119], v[16:19], v[40:43], v[104:119]
    ds_read_b64_tr_b16 v[16:17], v7 offset:2048
    ds_read_b64_tr_b16 v[18:19], v7 offset:3072
    s_waitcnt lgkmcnt(10)
    v_mfma_f32_32x32x16_bf16 v[120:135], v[20:23], v[40:43], v[120:135]
    ds_read_b64_tr_b16 v[20:21], v8 offset:2048
    ds_read_b64_tr_b16 v[22:23], v8 offset:3072
    s_waitcnt lgkmcnt(10)
    v_mfma_f32_32x32x16_bf16 v[136:151], v[24:27], v[40:43], v[136:151]
    ds_read_b64_tr_b16 v[24:25], v5 offset:4096
    ds_read_b64_tr_b16 v[26:27], v5 offset:5120
    s_waitcnt lgkmcnt(10)
    v_mfma_f32_32x32x16_bf16 v[152:167], v[28:31], v[40:43], v[152:167]
    ds_read_b64_tr_b16 v[28:29], v6 offset:4096
    ds_read_b64_tr_b16 v[30:31], v6 offset:5120
    s_waitcnt lgkmcnt(10)
    v_mfma_f32_32x32x16_bf16 v[104:119], v[32:35], v[44:47], v[104:119]
    ds_read_b64_tr_b16 v[32:33], v7 offset:4096
    ds_read_b64_tr_b16 v[34:35], v7 offset:5120
    s_waitcnt lgkmcnt(10)
    v_mfma_f32_32x32x16_bf16 v[120:135], v[36:39], v[44:47], v[120:135]
    ds_read_b64_tr_b16 v[36:37], v8 offset:4096
    ds_read_b64_tr_b16 v[38:39], v8 offset:5120
    s_waitcnt lgkmcnt(10)
    v_mfma_f32_32x32x16_bf16 v[136:151], v[16:19], v[44:47], v[136:151]
    ds_read_b64_tr_b16 v[16:17], v5 offset:6144
    ds_read_b64_tr_b16 v[18:19], v5 offset:7168
    s_waitcnt lgkmcnt(10)
    v_mfma_f32_32x32x16_bf16 v[152:167], v[20:23], v[44:47], v[152:167]
    ds_read_b64_tr_b16 v[20:21], v6 offset:6144
    ds_read_b64_tr_b16 v[22:23], v6 offset:7168
    s_waitcnt lgkmcnt(10)
    v_mfma_f32_32x32x16_bf16 v[104:119], v[24:27], v[48:51], v[104:119]
    ds_read_b64_tr_b16 v[24:25], v7 offset:6144
    ds_read_b64_tr_b16 v[26:27], v7 offset:7168
    s_waitcnt lgkmcnt(10)
    v_mfma_f32_32x32x16_bf16 v[120:135], v[28:31], v[48:51], v[120:135]
    ds_read_b64_tr_b16 v[28:29], v8 offset:6144
    ds_read_b64_tr_b16 v[30:31], v8 offset:7168
    s_waitcnt lgkmcnt(10)
    v_mfma_f32_32x32x16_bf16 v[136:151], v[32:35], v[48:51], v[136:151]
    s_waitcnt lgkmcnt(8)
    v_mfma_f32_32x32x16_bf16 v[152:167], v[36:39], v[48:51], v[152:167]
    s_waitcnt lgkmcnt(6)
    v_mfma_f32_32x32x16_bf16 v[104:119], v[16:19], v[52:55], v[104:119]
    s_waitcnt lgkmcnt(4)
    v_mfma_f32_32x32x16_bf16 v[120:135], v[20:23], v[52:55], v[120:135]
    s_waitcnt lgkmcnt(2)
    v_mfma_f32_32x32x16_bf16 v[136:151], v[24:27], v[52:55], v[136:151]
    s_waitcnt lgkmcnt(0)
    v_mfma_f32_32x32x16_bf16 v[152:167], v[28:31], v[52:55], v[152:167]
    v_add_u32 v5, 0x8000, v5
    v_add_u32 v6, 0x8000, v6
    v_add_u32 v7, 0x8000, v7
    v_add_u32 v8, 0x8000, v8
    s_mov_b32 s78, 24576
    buffer_load_dwordx4 v[40:43], v14, s[8:11], s78 offen offset:0
    buffer_load_dwordx4 v[44:47], v14, s[8:11], s78 offen offset:1024
    buffer_load_dwordx4 v[48:51], v14, s[8:11], s78 offen offset:2048
    buffer_load_dwordx4 v[52:55], v14, s[8:11], s78 offen offset:3072
    s_cmp_gt_u32 s4, 3
    s_cbranch_scc1 wn_13
    s_waitcnt vmcnt(16)
    s_branch wj_14
wn_13:
    s_waitcnt vmcnt(8)
wj_14:
    s_barrier
    s_cmp_gt_u32 s4, 3
    s_cbranch_scc1 nodma_15
    s_add_u32 m0, s24, 0
    s_add_u32 s25, s33, 0
    s_and_b32 s25, s25, 0x3ffff
    buffer_load_dwordx4 v1, s[16:19], s25 offen offset:0 nt lds
    buffer_load_dwordx4 v2, s[16:19], s25 offen offset:1024 nt lds
    buffer_load_dwordx4 v3, s[16:19], s25 offen offset:2048 nt lds
    buffer_load_dwordx4 v4, s[16:19], s25 offen offset:3072 nt lds
nodma_15:
    v_subrev_u32 v5, 0x8000, v5
    v_subrev_u32 v6, 0x8000, v6
    v_subrev_u32 v7, 0x8000, v7
    v_subrev_u32 v8, 0x8000, v8
    ds_read_b64_tr_b16 v[16:17], v5 offset:16384
    ds_read_b64_tr_b16 v[18:19], v5 offset:17408
    ds_read_b64_tr_b16 v[20:21], v6 offset:16384
    ds_read_b64_tr_b16 v[22:23], v6 offset:17408
    ds_read_b64_tr_b16 v[24:25], v7 offset:16384
    ds_read_b64_tr_b16 v[26:27], v7 offset:17408
    ds_read_b64_tr_b16 v[28:29], v8 offset:16384
    ds_read_b64_tr_b16 v[30:31], v8 offset:17408
    ds_read_b64_tr_b16 v[32:33], v5 offset:18432
    ds_read_b64_tr_b16 v[34:35], v5 offset:19456
    ds_read_b64_tr_b16 v[36:37], v6 offset:18432
    ds_read_b64_tr_b16 v[38:39], v6 offset:19456
    s_waitcnt lgkmcnt(10)
    v_mfma_f32_32x32x16_bf16 v[104:119], v[16:19], v[56:59], v[104:119]
    ds_read_b64_tr_b16 v[16:17], v7 offset:18432
    ds_read_b64_tr_b16 v[18:19], v7 offset:19456
    s_waitcnt lgkmcnt(10)
    v_mfma_f32_32x32x16_bf16 v[120:135], v[20:23], v[56:59], v[120:135]
    ds_read_b64_tr_b16 v[20:21], v8 offset:18432
    ds_read_b64_tr_b16 v[22:23], v8 offset:19456
    s_waitcnt lgkmcnt(10)
    v_mfma_f32_32x32x16_bf16 v[136:151], v[24:27], v[56:59], v[136:151]
    ds_read_b64_tr_b16 v[24:25], v5 offset:20480
    ds_read_b64_tr_b16 v[26:27], v5 offset:21504
    s_waitcnt lgkmcnt(10)
    v_mfma_f32_32x32x16_bf16 v[152:167], v[28:31], v[56:59], v[152:167]
    ds_read_b64_tr_b16 v[28:29], v6 offset:20480
    ds_read_b64_tr_b16 v[30:31], v6 offset:21504
    s_waitcnt lgkmcnt(10)
    v_mfma_f32_32x32x16_bf16 v[104:119], v[32:35], v[60:63], v[104:119]
    ds_read_b64_tr_b16 v[32:33], v7 offset:20480
    ds_read_b64_tr_b16 v[34:35], v7 offset:21504
    s_waitcnt lgkmcnt(10)
    v_mfma_f32_32x32x16_bf16 v[120:135], v[36:39], v[60:63], v[120:135]
    ds_read_b64_tr_b16 v[36:37], v8 offset:20480
    ds_read_b64_tr_b16 v[38:39], v8 offset:21504
    s_waitcnt lgkmcnt(10)
    v_mfma_f32_32x32x16_bf16 v[136:151], v[16:19], v[60:63], v[136:151]
    ds_read_b64_tr_b16 v[16:17], v5 offset:22528
    ds_read_b64_tr_b16 v[18:19], v5 offset:23552
    s_waitcnt lgkmcnt(10)
    v_mfma_f32_32x32x16_bf16 v[152:167], v[20:23], v[60:63], v[152:167]
    ds_read_b64_tr_b16 v[20:21], v6 offset:22528
    ds_read_b64_tr_b16 v[22:23], v6 offset:23552
    s_waitcnt lgkmcnt(10)
    v_mfma_f32_32x32x16_bf16 v[104:119], v[24:27], v[64:67], v[104:119]
    ds_read_b64_tr_b16 v[24:25], v7 offset:22528
    ds_read_b64_tr_b16 v[26:27], v7 offset:23552
    s_waitcnt lgkmcnt(10)
    v_mfma_f32_32x32x16_bf16 v[120:135], v[28:31], v[64:67], v[120:135]
    ds_read_b64_tr_b16 v[28:29], v8 offset:22528
    ds_read_b64_tr_b16 v[30:31], v8 offset:23552
    s_waitcnt lgkmcnt(10)
    v_mfma_f32_32x32x16_bf16 v[136:151], v[32:35], v[64:67], v[136:151]
    s_waitcnt lgkmcnt(8)
    v_mfma_f32_32x32x16_bf16 v[152:167], v[36:39], v[64:67], v[152:167]
    s_waitcnt lgkmcnt(6)
    v_mfma_f32_32x32x16_bf16 v[104:119], v[16:19], v[68:71], v[104:119]
    s_waitcnt lgkmcnt(4)
    v_mfma_f32_32x32x16_bf16 v[120:135], v[20:23], v[68:71], v[120:135]
    s_waitcnt lgkmcnt(2)
    v_mfma_f32_32x32x16_bf16 v[136:151], v[24:27], v[68:71], v[136:151]
    s_waitcnt lgkmcnt(0)
    v_mfma_f32_32x32x16_bf16 v[152:167], v[28:31], v[68:71], v[152:167]
    v_add_u32 v5, 0x8000, v5
    v_add_u32 v6, 0x8000, v6
    v_add_u32 v7, 0x8000, v7
    v_add_u32 v8, 0x8000, v8
    s_mov_b32 s78, 28672
    buffer_load_dwordx4 v[56:59], v14, s[8:11], s78 offen offset:0
    buffer_load_dwordx4 v[60:63], v14, s[8:11], s78 offen offset:1024
    buffer_load_dwordx4 v[64:67], v14, s[8:11], s78 offen offset:2048
    buffer_load_dwordx4 v[68:71], v14, s[8:11], s78 offen offset:3072
    s_cmp_gt_u32 s4, 3
    s_cbranch_scc1 wn_16
    s_waitcnt vmcnt(16)
    s_branch wj_17
wn_16:
    s_waitcnt vmcnt(8)
wj_17:
    s_barrier
    s_cmp_gt_u32 s4, 3
    s_cbranch_scc1 nodma_18
    s_add_u32 m0, s24, 16384
    s_add_u32 s25, s33, 8192
    s_and_b32 s25, s25, 0x3ffff
    buffer_load_dwordx4 v1, s[16:19], s25 offen offset:0 nt lds
    buffer_load_dwordx4 v2, s[16:19], s25 offen offset:1024 nt lds
    buffer_load_dwordx4 v3, s[16:19], s25 offen offset:2048 nt lds
    buffer_load_dwordx4 v4, s[16:19], s25 offen offset:3072 nt lds
nodma_18:
    ds_read_b64_tr_b16 v[16:17], v5 offset:0
    ds_read_b64_tr_b16 v[18:19], v5 offset:1024
    ds_read_b64_tr_b16 v[20:21], v6 offset:0
    ds_read_b64_tr_b16 v[22:23], v6 offset:1024
    ds_read_b64_tr_b16 v[24:25], v7 offset:0
    ds_read_b64_tr_b16 v[26:27], v7 offset:1024
    ds_read_b64_tr_b16 v[28:29], v8 offset:0
    ds_read_b64_tr_b16 v[30:31], v8 offset:1024
    ds_read_b64_tr_b16 v[32:33], v5 offset:2048
    ds_read_b64_tr_b16 v[34:35], v5 offset:3072
    ds_read_b64_tr_b16 v[36:37], v6 offset:2048
    ds_read_b64_tr_b16 v[38:39], v6 offset:3072
    s_waitcnt lgkmcnt(10)
    v_mfma_f32_32x32x16_bf16 v[104:119], v[16:19], v[72:75], v[104:119]
    ds_read_b64_tr_b16 v[16:17], v7 offset:2048
    ds_read_b64_tr_b16 v[18:19], v7 offset:3072
    s_waitcnt lgkmcnt(10)
    v_mfma_f32_32x32x16_bf16 v[120:135], v[20:23], v[72:75], v[120:135]
    ds_read_b64_tr_b16 v[20:21], v8 offset:2048
    ds_read_b64_tr_b16 v[22:23], v8 offset:3072
    s_waitcnt lgkmcnt(10)
    v_mfma_f32_32x32x16_bf16 v[136:151], v[24:27], v[72:75], v[136:151]
    ds_read_b64_tr_b16 v[24:25], v5 offset:4096
    ds_read_b64_tr_b16 v[26:27], v5 offset:5120
    s_waitcnt lgkmcnt(10)
    v_mfma_f32_32x32x16_bf16 v[152:167], v[28:31], v[72:75], v[152:167]
    ds_read_b64_tr_b16 v[28:29], v6 offset:4096
    ds_read_b64_tr_b16 v[30:31], v6 offset:5120
    s_waitcnt lgkmcnt(10)
    v_mfma_f32_32x32x16_bf16 v[104:119], v[32:35], v[76:79], v[104:119]
    ds_read_b64_tr_b16 v[32:33], v7 offset:4096
    ds_read_b64_tr_b16 v[34:35], v7 offset:5120
    s_waitcnt lgkmcnt(10)
    v_mfma_f32_32x32x16_bf16 v[120:135], v[36:39], v[76:79], v[120:135]
    ds_read_b64_tr_b16 v[36:37], v8 offset:4096
    ds_read_b64_tr_b16 v[38:39], v8 offset:5120
    s_waitcnt lgkmcnt(10)
    v_mfma_f32_32x32x16_bf16 v[136:151], v[16:19], v[76:79], v[136:151]
    ds_read_b64_tr_b16 v[16:17], v5 offset:6144
    ds_read_b64_tr_b16 v[18:19], v5 offset:7168
    s_waitcnt lgkmcnt(10)
    v_mfma_f32_32x32x16_bf16 v[152:167], v[20:23], v[76:79], v[152:167]
    ds_read_b64_tr_b16 v[20:21], v6 offset:6144
    ds_read_b64_tr_b16 v[22:23], v6 offset:7168
    s_waitcnt lgkmcnt(10)
    v_mfma_f32_32x32x16_bf16 v[104:119], v[24:27], v[80:83], v[104:119]
    ds_read_b64_tr_b16 v[24:25], v7 offset:6144
    ds_read_b64_tr_b16 v[26:27], v7 offset:7168
    s_waitcnt lgkmcnt(10)
    v_mfma_f32_32x32x16_bf16 v[120:135], v[28:31], v[80:83], v[120:135]
    ds_read_b64_tr_b16 v[28:29], v8 offset:6144
    ds_read_b64_tr_b16 v[30:31], v8 offset:7168
    s_waitcnt lgkmcnt(10)
    v_mfma_f32_32x32x16_bf16 v[136:151], v[32:35], v[80:83], v[136:151]
    s_waitcnt lgkmcnt(8)
    v_mfma_f32_32x32x16_bf16 v[152:167], v[36:39], v[80:83], v[152:167]
    s_waitcnt lgkmcnt(6)
    v_mfma_f32_32x32x16_bf16 v[104:119], v[16:19], v[84:87], v[104:119]
    s_waitcnt lgkmcnt(4)
    v_mfma_f32_32x32x16_bf16 v[120:135], v[20:23], v[84:87], v[120:135]
    s_waitcnt lgkmcnt(2)
    v_mfma_f32_32x32x16_bf16 v[136:151], v[24:27], v[84:87], v[136:151]
    s_waitcnt lgkmcnt(0)
    v_mfma_f32_32x32x16_bf16 v[152:167], v[28:31], v[84:87], v[152:167]
    s_cmp_gt_u32 s4, 3
    s_cbranch_scc1 wn_19
    s_waitcnt vmcnt(12)
    s_branch wj_20
wn_19:
    s_waitcnt vmcnt(4)
wj_20:
    s_barrier
    s_cmp_gt_u32 s4, 3
    s_cbranch_scc1 nodma_21
    s_add_u32 m0, s24, 32768
    s_add_u32 s25, s33, 16384
    s_and_b32 s25, s25, 0x3ffff
    buffer_load_dwordx4 v1, s[16:19], s25 offen offset:0 nt lds
    buffer_load_dwordx4 v2, s[16:19], s25 offen offset:1024 nt lds
    buffer_load_dwordx4 v3, s[16:19], s25 offen offset:2048 nt lds
    buffer_load_dwordx4 v4, s[16:19], s25 offen offset:3072 nt lds
nodma_21:
    ds_read_b64_tr_b16 v[16:17], v5 offset:16384
    ds_read_b64_tr_b16 v[18:19], v5 offset:17408
    ds_read_b64_tr_b16 v[20:21], v6 offset:16384
    ds_read_b64_tr_b16 v[22:23], v6 offset:17408
    ds_read_b64_tr_b16 v[24:25], v7 offset:16384
    ds_read_b64_tr_b16 v[26:27], v7 offset:17408
    ds_read_b64_tr_b16 v[28:29], v8 offset:16384
    ds_read_b64_tr_b16 v[30:31], v8 offset:17408
    ds_read_b64_tr_b16 v[32:33], v5 offset:18432
    ds_read_b64_tr_b16 v[34:35], v5 offset:19456
    ds_read_b64_tr_b16 v[36:37], v6 offset:18432
    ds_read_b64_tr_b16 v[38:39], v6 offset:19456
    s_waitcnt lgkmcnt(10)
    v_mfma_f32_32x32x16_bf16 v[104:119], v[16:19], v[40:43], v[104:119]
    ds_read_b64_tr_b16 v[16:17], v7 offset:18432
    ds_read_b64_tr_b16 v[18:19], v7 offset:19456
    s_waitcnt lgkmcnt(10)
    v_mfma_f32_32x32x16_bf16 v[120:135], v[20:23], v[40:43], v[120:135]
    ds_read_b64_tr_b16 v[20:21], v8 offset:18432
    ds_read_b64_tr_b16 v[22:23], v8 offset:19456
    s_waitcnt lgkmcnt(10)
    v_mfma_f32_32x32x16_bf16 v[136:151], v[24:27], v[40:43], v[136:151]
    ds_read_b64_tr_b16 v[24:25], v5 offset:20480
    ds_read_b64_tr_b16 v[26:27], v5 offset:21504
    s_waitcnt lgkmcnt(10)
    v_mfma_f32_32x32x16_bf16 v[152:167], v[28:31], v[40:43], v[152:167]
    ds_read_b64_tr_b16 v[28:29], v6 offset:20480
    ds_read_b64_tr_b16 v[30:31], v6 offset:21504
    s_waitcnt lgkmcnt(10)
    v_mfma_f32_32x32x16_bf16 v[104:119], v[32:35], v[44:47], v[104:119]
    ds_read_b64_tr_b16 v[32:33], v7 offset:20480
    ds_read_b64_tr_b16 v[34:35], v7 offset:21504
    s_waitcnt lgkmcnt(10)
    v_mfma_f32_32x32x16_bf16 v[120:135], v[36:39], v[44:47], v[120:135]
    ds_read_b64_tr_b16 v[36:37], v8 offset:20480
    ds_read_b64_tr_b16 v[38:39], v8 offset:21504
    s_waitcnt lgkmcnt(10)
    v_mfma_f32_32x32x16_bf16 v[136:151], v[16:19], v[44:47], v[136:151]
    ds_read_b64_tr_b16 v[16:17], v5 offset:22528
    ds_read_b64_tr_b16 v[18:19], v5 offset:23552
    s_waitcnt lgkmcnt(10)
    v_mfma_f32_32x32x16_bf16 v[152:167], v[20:23], v[44:47], v[152:167]
    ds_read_b64_tr_b16 v[20:21], v6 offset:22528
    ds_read_b64_tr_b16 v[22:23], v6 offset:23552
    s_waitcnt lgkmcnt(10)
    v_mfma_f32_32x32x16_bf16 v[104:119], v[24:27], v[48:51], v[104:119]
    ds_read_b64_tr_b16 v[24:25], v7 offset:22528
    ds_read_b64_tr_b16 v[26:27], v7 offset:23552
    s_waitcnt lgkmcnt(10)
    v_mfma_f32_32x32x16_bf16 v[120:135], v[28:31], v[48:51], v[120:135]
    ds_read_b64_tr_b16 v[28:29], v8 offset:22528
    ds_read_b64_tr_b16 v[30:31], v8 offset:23552
    s_waitcnt lgkmcnt(10)
    v_mfma_f32_32x32x16_bf16 v[136:151], v[32:35], v[48:51], v[136:151]
    s_waitcnt lgkmcnt(8)
    v_mfma_f32_32x32x16_bf16 v[152:167], v[36:39], v[48:51], v[152:167]
    s_waitcnt lgkmcnt(6)
    v_mfma_f32_32x32x16_bf16 v[104:119], v[16:19], v[52:55], v[104:119]
    s_waitcnt lgkmcnt(4)
    v_mfma_f32_32x32x16_bf16 v[120:135], v[20:23], v[52:55], v[120:135]
    s_waitcnt lgkmcnt(2)
    v_mfma_f32_32x32x16_bf16 v[136:151], v[24:27], v[52:55], v[136:151]
    s_waitcnt lgkmcnt(0)
    v_mfma_f32_32x32x16_bf16 v[152:167], v[28:31], v[52:55], v[152:167]
    s_cmp_gt_u32 s4, 3
    s_cbranch_scc1 wn_22
    s_waitcnt vmcnt(8)
    s_branch wj_23
wn_22:
    s_waitcnt vmcnt(0)
wj_23:
    s_barrier
    s_cmp_gt_u32 s4, 3
    s_cbranch_scc1 nodma_24
    s_add_u32 m0, s24, 49152
    s_add_u32 s25, s33, 24576
    s_and_b32 s25, s25, 0x3ffff
    buffer_load_dwordx4 v1, s[16:19], s25 offen offset:0 nt lds
    buffer_load_dwordx4 v2, s[16:19], s25 offen offset:1024 nt lds
    buffer_load_dwordx4 v3, s[16:19], s25 offen offset:2048 nt lds
    buffer_load_dwordx4 v4, s[16:19], s25 offen offset:3072 nt lds
nodma_24:
    v_add_u32 v5, 0x8000, v5
    v_add_u32 v6, 0x8000, v6
    v_add_u32 v7, 0x8000, v7
    v_add_u32 v8, 0x8000, v8
    ds_read_b64_tr_b16 v[16:17], v5 offset:0
    ds_read_b64_tr_b16 v[18:19], v5 offset:1024
    ds_read_b64_tr_b16 v[20:21], v6 offset:0
    ds_read_b64_tr_b16 v[22:23], v6 offset:1024
    ds_read_b64_tr_b16 v[24:25], v7 offset:0
    ds_read_b64_tr_b16 v[26:27], v7 offset:1024
    ds_read_b64_tr_b16 v[28:29], v8 offset:0
    ds_read_b64_tr_b16 v[30:31], v8 offset:1024
    ds_read_b64_tr_b16 v[32:33], v5 offset:2048
    ds_read_b64_tr_b16 v[34:35], v5 offset:3072
    ds_read_b64_tr_b16 v[36:37], v6 offset:2048
    ds_read_b64_tr_b16 v[38:39], v6 offset:3072
    s_waitcnt lgkmcnt(10)
    v_mfma_f32_32x32x16_bf16 v[104:119], v[16:19], v[56:59], v[104:119]
    ds_read_b64_tr_b16 v[16:17], v7 offset:2048
    ds_read_b64_tr_b16 v[18:19], v7 offset:3072
    s_waitcnt lgkmcnt(10)
    v_mfma_f32_32x32x16_bf16 v[120:135], v[20:23], v[56:59], v[120:135]
    ds_read_b64_tr_b16 v[20:21], v8 offset:2048
    ds_read_b64_tr_b16 v[22:23], v8 offset:3072
    s_waitcnt lgkmcnt(10)
    v_mfma_f32_32x32x16_bf16 v[136:151], v[24:27], v[56:59], v[136:151]
    ds_read_b64_tr_b16 v[24:25], v5 offset:4096
    ds_read_b64_tr_b16 v[26:27], v5 offset:5120
    s_waitcnt lgkmcnt(10)
    v_mfma_f32_32x32x16_bf16 v[152:167], v[28:31], v[56:59], v[152:167]
    ds_read_b64_tr_b16 v[28:29], v6 offset:4096
    ds_read_b64_tr_b16 v[30:31], v6 offset:5120
    s_waitcnt lgkmcnt(10)
    v_mfma_f32_32x32x16_bf16 v[104:119], v[32:35], v[60:63], v[104:119]
    ds_read_b64_tr_b16 v[32:33], v7 offset:4096
    ds_read_b64_tr_b16 v[34:35], v7 offset:5120
    s_waitcnt lgkmcnt(10)
    v_mfma_f32_32x32x16_bf16 v[120:135], v[36:39], v[60:63], v[120:135]
    ds_read_b64_tr_b16 v[36:37], v8 offset:4096
    ds_read_b64_tr_b16 v[38:39], v8 offset:5120
    s_waitcnt lgkmcnt(10)
    v_mfma_f32_32x32x16_bf16 v[136:151], v[16:19], v[60:63], v[136:151]
    ds_read_b64_tr_b16 v[16:17], v5 offset:6144
    ds_read_b64_tr_b16 v[18:19], v5 offset:7168
    s_waitcnt lgkmcnt(10)
    v_mfma_f32_32x32x16_bf16 v[152:167], v[20:23], v[60:63], v[152:167]
    ds_read_b64_tr_b16 v[20:21], v6 offset:6144
    ds_read_b64_tr_b16 v[22:23], v6 offset:7168
    s_waitcnt lgkmcnt(10)
    v_mfma_f32_32x32x16_bf16 v[104:119], v[24:27], v[64:67], v[104:119]
    ds_read_b64_tr_b16 v[24:25], v7 offset:6144
    ds_read_b64_tr_b16 v[26:27], v7 offset:7168
    s_waitcnt lgkmcnt(10)
    v_mfma_f32_32x32x16_bf16 v[120:135], v[28:31], v[64:67], v[120:135]
    ds_read_b64_tr_b16 v[28:29], v8 offset:6144
    ds_read_b64_tr_b16 v[30:31], v8 offset:7168
    s_waitcnt lgkmcnt(10)
    v_mfma_f32_32x32x16_bf16 v[136:151], v[32:35], v[64:67], v[136:151]
    s_waitcnt lgkmcnt(8)
    v_mfma_f32_32x32x16_bf16 v[152:167], v[36:39], v[64:67], v[152:167]
    s_waitcnt lgkmcnt(6)
    v_mfma_f32_32x32x16_bf16 v[104:119], v[16:19], v[68:71], v[104:119]
    s_waitcnt lgkmcnt(4)
    v_mfma_f32_32x32x16_bf16 v[120:135], v[20:23], v[68:71], v[120:135]
    s_waitcnt lgkmcnt(2)
    v_mfma_f32_32x32x16_bf16 v[136:151], v[24:27], v[68:71], v[136:151]
    s_waitcnt lgkmcnt(0)
    v_mfma_f32_32x32x16_bf16 v[152:167], v[28:31], v[68:71], v[152:167]
    v_subrev_u32 v5, 0x8000, v5
    v_subrev_u32 v6, 0x8000, v6
    v_subrev_u32 v7, 0x8000, v7
    v_subrev_u32 v8, 0x8000, v8
    s_nop 15
    v_mul_f32 v104, s28, v104
    v_mul_f32 v105, s28, v105
    v_mul_f32 v106, s28, v106
    v_mul_f32 v107, s28, v107
    v_mul_f32 v108, s28, v108
    v_mul_f32 v109, s28, v109
    v_mul_f32 v110, s28, v110
    v_mul_f32 v111, s28, v111
    v_mul_f32 v112, s28, v112
    v_mul_f32 v113, s28, v113
    v_mul_f32 v114, s28, v114
    v_mul_f32 v115, s28, v115
    v_mul_f32 v116, s28, v116
    v_mul_f32 v117, s28, v117
    v_mul_f32 v118, s28, v118
    v_mul_f32 v119, s28, v119
    v_mul_f32 v120, s28, v120
    v_mul_f32 v121, s28, v121
    v_mul_f32 v122, s28, v122
    v_mul_f32 v123, s28, v123
    v_mul_f32 v124, s28, v124
    v_mul_f32 v125, s28, v125
    v_mul_f32 v126, s28, v126
    v_mul_f32 v127, s28, v127
    v_mul_f32 v128, s28, v128
    v_mul_f32 v129, s28, v129
    v_mul_f32 v130, s28, v130
    v_mul_f32 v131, s28, v131
    v_mul_f32 v132, s28, v132
    v_mul_f32 v133, s28, v133
    v_mul_f32 v134, s28, v134
    v_mul_f32 v135, s28, v135
    v_mul_f32 v136, s28, v136
    v_mul_f32 v137, s28, v137
    v_mul_f32 v138, s28, v138
    v_mul_f32 v139, s28, v139
    v_mul_f32 v140, s28, v140
    v_mul_f32 v141, s28, v141
    v_mul_f32 v142, s28, v142
    v_mul_f32 v143, s28, v143
    v_mul_f32 v144, s28, v144
    v_mul_f32 v145, s28, v145
    v_mul_f32 v146, s28, v146
    v_mul_f32 v147, s28, v147
    v_mul_f32 v148, s28, v148
    v_mul_f32 v149, s28, v149
    v_mul_f32 v150, s28, v150
    v_mul_f32 v151, s28, v151
    v_mul_f32 v152, s28, v152
    v_mul_f32 v153, s28, v153
    v_mul_f32 v154, s28, v154
    v_mul_f32 v155, s28, v155
    v_mul_f32 v156, s28, v156
    v_mul_f32 v157, s28, v157
    v_mul_f32 v158, s28, v158
    v_mul_f32 v159, s28, v159
    v_mul_f32 v160, s28, v160
    v_mul_f32 v161, s28, v161
    v_mul_f32 v162, s28, v162
    v_mul_f32 v163, s28, v163
    v_mul_f32 v164, s28, v164
    v_mul_f32 v165, s28, v165
    v_mul_f32 v166, s28, v166
    v_mul_f32 v167, s28, v167
    v_cvt_pk_bf16_f32 v72, v104, v105
    v_cvt_pk_bf16_f32 v73, v106, v107
    v_cvt_pk_bf16_f32 v74, v108, v109
    v_cvt_pk_bf16_f32 v75, v110, v111
    v_cvt_pk_bf16_f32 v76, v112, v113
    v_cvt_pk_bf16_f32 v77, v114, v115
    v_cvt_pk_bf16_f32 v78, v116, v117
    v_cvt_pk_bf16_f32 v79, v118, v119
    v_cvt_pk_bf16_f32 v80, v120, v121
    v_cvt_pk_bf16_f32 v81, v122, v123
    v_cvt_pk_bf16_f32 v82, v124, v125
    v_cvt_pk_bf16_f32 v83, v126, v127
    v_cvt_pk_bf16_f32 v84, v128, v129
    v_cvt_pk_bf16_f32 v85, v130, v131
    v_cvt_pk_bf16_f32 v86, v132, v133
    v_cvt_pk_bf16_f32 v87, v134, v135
    v_cvt_pk_bf16_f32 v88, v136, v137
    v_cvt_pk_bf16_f32 v89, v138, v139
    v_cvt_pk_bf16_f32 v90, v140, v141
    v_cvt_pk_bf16_f32 v91, v142, v143
    v_cvt_pk_bf16_f32 v92, v144, v145
    v_cvt_pk_bf16_f32 v93, v146, v147
    v_cvt_pk_bf16_f32 v94, v148, v149
    v_cvt_pk_bf16_f32 v95, v150, v151
    v_cvt_pk_bf16_f32 v96, v152, v153
    v_cvt_pk_bf16_f32 v97, v154, v155
    v_cvt_pk_bf16_f32 v98, v156, v157
    v_cvt_pk_bf16_f32 v99, v158, v159
    v_cvt_pk_bf16_f32 v100, v160, v161
    v_cvt_pk_bf16_f32 v101, v162, v163
    v_cvt_pk_bf16_f32 v102, v164, v165
    v_cvt_pk_bf16_f32 v103, v166, v167
    v_mov_b32 v104, 0
    v_mov_b32 v105, 0
    v_mov_b32 v106, 0
    v_mov_b32 v107, 0
    v_mov_b32 v108, 0
    v_mov_b32 v109, 0
    v_mov_b32 v110, 0
    v_mov_b32 v111, 0
    v_mov_b32 v112, 0
    v_mov_b32 v113, 0
    v_mov_b32 v114, 0
    v_mov_b32 v115, 0
    v_mov_b32 v116, 0
    v_mov_b32 v117, 0
    v_mov_b32 v118, 0
    v_mov_b32 v119, 0
    v_mov_b32 v120, 0
    v_mov_b32 v121, 0
    v_mov_b32 v122, 0
    v_mov_b32 v123, 0
    v_mov_b32 v124, 0
    v_mov_b32 v125, 0
    v_mov_b32 v126, 0
    v_mov_b32 v127, 0
    v_mov_b32 v128, 0
    v_mov_b32 v129, 0
    v_mov_b32 v130, 0
    v_mov_b32 v131, 0
    v_mov_b32 v132, 0
    v_mov_b32 v133, 0
    v_mov_b32 v134, 0
    v_mov_b32 v135, 0
    v_mov_b32 v136, 0
    v_mov_b32 v137, 0
    v_mov_b32 v138, 0
    v_mov_b32 v139, 0
    v_mov_b32 v140, 0
    v_mov_b32 v141, 0
    v_mov_b32 v142, 0
    v_mov_b32 v143, 0
    v_mov_b32 v144, 0
    v_mov_b32 v145, 0
    v_mov_b32 v146, 0
    v_mov_b32 v147, 0
    v_mov_b32 v148, 0
    v_mov_b32 v149, 0
    v_mov_b32 v150, 0
    v_mov_b32 v151, 0
    v_mov_b32 v152, 0
    v_mov_b32 v153, 0
    v_mov_b32 v154, 0
    v_mov_b32 v155, 0
    v_mov_b32 v156, 0
    v_mov_b32 v157, 0
    v_mov_b32 v158, 0
    v_mov_b32 v159, 0
    v_mov_b32 v160, 0
    v_mov_b32 v161, 0
    v_mov_b32 v162, 0
    v_mov_b32 v163, 0
    v_mov_b32 v164, 0
    v_mov_b32 v165, 0
    v_mov_b32 v166, 0
    v_mov_b32 v167, 0
    v_sub_u32 v5, v5, v12
    v_sub_u32 v6, v6, v12
    v_sub_u32 v7, v7, v12
    v_sub_u32 v8, v8, v12
    v_mov_b32 v11, 0
    s_waitcnt vmcnt(12)
    s_barrier
    ds_read_b128 v[16:19], v9 offset:0
    v_xor_b32 v15, 16, v9
    ds_read_b128 v[20:23], v15 offset:0
    v_xor_b32 v15, 32, v9
    ds_read_b128 v[24:27], v15 offset:0
    v_xor_b32 v15, 48, v9
    ds_read_b128 v[28:31], v15 offset:0
    v_xor_b32 v15, 64, v9
    ds_read_b128 v[32:35], v15 offset:0
    v_xor_b32 v15, 80, v9
    ds_read_b128 v[36:39], v15 offset:0
    s_waitcnt lgkmcnt(5)
    v_mfma_f32_32x32x16_bf16 v[40:55], v[16:19], v[72:75], 0
    v_xor_b32 v15, 96, v9
    ds_read_b128 v[16:19], v15 offset:0
    s_waitcnt lgkmcnt(5)
    v_mfma_f32_32x32x16_bf16 v[40:55], v[20:23], v[76:79], v[40:55]
    v_xor_b32 v15, 112, v9
    ds_read_b128 v[20:23], v15 offset:0
    s_waitcnt lgkmcnt(5)
    v_mfma_f32_32x32x16_bf16 v[40:55], v[24:27], v[80:83], v[40:55]
    ds_read_b64_tr_b16 v[24:25], v5 offset:8192
    ds_read_b64_tr_b16 v[26:27], v5 offset:10240
    s_waitcnt lgkmcnt(6)
    v_mfma_f32_32x32x16_bf16 v[40:55], v[28:31], v[84:87], v[40:55]
    ds_read_b64_tr_b16 v[28:29], v6 offset:8192
    ds_read_b64_tr_b16 v[30:31], v6 offset:10240
    s_waitcnt lgkmcnt(7)
    v_mfma_f32_32x32x16_bf16 v[40:55], v[32:35], v[88:91], v[40:55]
    ds_read_b64_tr_b16 v[32:33], v7 offset:8192
    ds_read_b64_tr_b16 v[34:35], v7 offset:10240
    s_waitcnt lgkmcnt(8)
    v_mfma_f32_32x32x16_bf16 v[40:55], v[36:39], v[92:95], v[40:55]
    ds_read_b64_tr_b16 v[36:37], v8 offset:8192
    ds_read_b64_tr_b16 v[38:39], v8 offset:10240
    s_waitcnt lgkmcnt(9)
    v_mfma_f32_32x32x16_bf16 v[40:55], v[16:19], v[96:99], v[40:55]
    ds_read_b64_tr_b16 v[16:17], v5 offset:12288
    ds_read_b64_tr_b16 v[18:19], v5 offset:14336
    s_waitcnt lgkmcnt(10)
    v_mfma_f32_32x32x16_bf16 v[40:55], v[20:23], v[100:103], v[40:55]
    s_nop 11
    v_max3_f32 v13, v40, v41, v42
    v_max3_f32 v14, v43, v44, v45
    v_max3_f32 v13, v13, v46, v47
    v_max3_f32 v14, v14, v48, v49
    v_max3_f32 v13, v13, v50, v51
    v_max3_f32 v14, v14, v52, v53
    v_max3_f32 v13, v13, v54, v55
    v_max_f32 v13, v13, v14
    v_mov_b32 v14, v13
    s_nop 1
    v_permlane32_swap_b32 v13, v14
    v_max_f32 v13, v13, v14
    v_sub_f32 v56, 0, v13
    v_sub_f32 v57, 0, v13
    v_sub_f32 v58, 0, v13
    v_sub_f32 v59, 0, v13
    v_sub_f32 v60, 0, v13
    v_sub_f32 v61, 0, v13
    v_sub_f32 v62, 0, v13
    v_sub_f32 v63, 0, v13
    v_sub_f32 v64, 0, v13
    v_sub_f32 v65, 0, v13
    v_sub_f32 v66, 0, v13
    v_sub_f32 v67, 0, v13
    v_sub_f32 v68, 0, v13
    v_sub_f32 v69, 0, v13
    v_sub_f32 v70, 0, v13
    v_sub_f32 v71, 0, v13
    v_sub_f32 v40, v40, v13
    v_sub_f32 v41, v41, v13
    v_sub_f32 v42, v42, v13
    v_sub_f32 v43, v43, v13
    v_sub_f32 v44, v44, v13
    v_sub_f32 v45, v45, v13
    v_sub_f32 v46, v46, v13
    v_sub_f32 v47, v47, v13
    v_sub_f32 v48, v48, v13
    v_sub_f32 v49, v49, v13
    v_sub_f32 v50, v50, v13
    v_sub_f32 v51, v51, v13
    v_sub_f32 v52, v52, v13
    v_sub_f32 v53, v53, v13
    v_sub_f32 v54, v54, v13
    v_sub_f32 v55, v55, v13
    v_exp_f32 v40, v40
    v_exp_f32 v41, v41
    v_exp_f32 v42, v42
    v_exp_f32 v43, v43
    v_exp_f32 v44, v44
    v_exp_f32 v45, v45
    v_exp_f32 v46, v46
    v_exp_f32 v47, v47
    v_exp_f32 v48, v48
    v_exp_f32 v49, v49
    v_exp_f32 v50, v50
    v_exp_f32 v51, v51
    v_exp_f32 v52, v52
    v_exp_f32 v53, v53
    v_exp_f32 v54, v54
    v_exp_f32 v55, v55
    s_nop 0
    v_cvt_pk_bf16_f32 v40, v40, v41
    v_cvt_pk_bf16_f32 v41, v42, v43
    v_cvt_pk_bf16_f32 v42, v44, v45
    v_cvt_pk_bf16_f32 v43, v46, v47
    v_cvt_pk_bf16_f32 v44, v48, v49
    v_cvt_pk_bf16_f32 v45, v50, v51
    v_cvt_pk_bf16_f32 v46, v52, v53
    v_cvt_pk_bf16_f32 v47, v54, v55
    v_dot2c_f32_bf16 v11, s37, v40
    v_dot2c_f32_bf16 v11, s37, v41
    v_dot2c_f32_bf16 v11, s37, v42
    v_dot2c_f32_bf16 v11, s37, v43
    v_dot2c_f32_bf16 v11, s37, v44
    v_dot2c_f32_bf16 v11, s37, v45
    v_dot2c_f32_bf16 v11, s37, v46
    v_dot2c_f32_bf16 v11, s37, v47
    ds_read_b64_tr_b16 v[20:21], v6 offset:12288
    ds_read_b64_tr_b16 v[22:23], v6 offset:14336
    s_waitcnt lgkmcnt(10)
    v_mfma_f32_32x32x16_bf16 v[104:119], v[24:27], v[40:43], v[104:119]
    ds_read_b64_tr_b16 v[24:25], v7 offset:12288
    ds_read_b64_tr_b16 v[26:27], v7 offset:14336
    s_waitcnt lgkmcnt(10)
    v_mfma_f32_32x32x16_bf16 v[120:135], v[28:31], v[40:43], v[120:135]
    ds_read_b64_tr_b16 v[28:29], v8 offset:12288
    ds_read_b64_tr_b16 v[30:31], v8 offset:14336
    s_waitcnt lgkmcnt(10)
    v_mfma_f32_32x32x16_bf16 v[136:151], v[32:35], v[40:43], v[136:151]
    s_waitcnt lgkmcnt(8)
    v_mfma_f32_32x32x16_bf16 v[152:167], v[36:39], v[40:43], v[152:167]
    s_waitcnt lgkmcnt(6)
    v_mfma_f32_32x32x16_bf16 v[104:119], v[16:19], v[44:47], v[104:119]
    s_waitcnt lgkmcnt(4)
    v_mfma_f32_32x32x16_bf16 v[120:135], v[20:23], v[44:47], v[120:135]
    s_waitcnt lgkmcnt(2)
    v_mfma_f32_32x32x16_bf16 v[136:151], v[24:27], v[44:47], v[136:151]
    s_waitcnt lgkmcnt(0)
    v_mfma_f32_32x32x16_bf16 v[152:167], v[28:31], v[44:47], v[152:167]
    s_add_u32 s26, s33, 32768
    s_and_b32 s26, s26, 0x3ffff
    s_mov_b32 s27, 0
att_loop:
    s_waitcnt vmcnt(8)
    s_barrier
    s_cmp_gt_u32 s4, 3
    s_cbranch_scc1 nodma_25
    s_add_u32 m0, s24, 0
    s_nop 0
    buffer_load_dwordx4 v1, s[16:19], s26 offen offset:0 nt lds
    buffer_load_dwordx4 v2, s[16:19], s26 offen offset:1024 nt lds
    buffer_load_dwordx4 v3, s[16:19], s26 offen offset:2048 nt lds
    buffer_load_dwordx4 v4, s[16:19], s26 offen offset:3072 nt lds
nodma_25:
    s_add_u32 s26, s26, 8192
    s_and_b32 s26, s26, 0x3ffff
    ds_read_b128 v[16:19], v9 offset:16384
    v_xor_b32 v15, 16, v9
    ds_read_b128 v[20:23], v15 offset:16384
    v_xor_b32 v15, 32, v9
    ds_read_b128 v[24:27], v15 offset:16384
    v_xor_b32 v15, 48, v9
    ds_read_b128 v[28:31], v15 offset:16384
    v_xor_b32 v15, 64, v9
    ds_read_b128 v[32:35], v15 offset:16384
    v_xor_b32 v15, 80, v9
    ds_read_b128 v[36:39], v15 offset:16384
    s_waitcnt lgkmcnt(5)
    v_mfma_f32_32x32x16_bf16 v[40:55], v[16:19], v[72:75], v[56:71]
    v_xor_b32 v15, 96, v9
    ds_read_b128 v[16:19], v15 offset:16384
    s_waitcnt lgkmcnt(5)
    v_mfma_f32_32x32x16_bf16 v[40:55], v[20:23], v[76:79], v[40:55]
    v_xor_b32 v15, 112, v9
    ds_read_b128 v[20:23], v15 offset:16384
    s_waitcnt lgkmcnt(5)
    v_mfma_f32_32x32x16_bf16 v[40:55], v[24:27], v[80:83], v[40:55]
    ds_read_b64_tr_b16 v[24:25], v5 offset:24576
    ds_read_b64_tr_b16 v[26:27], v5 offset:26624
    s_waitcnt lgkmcnt(6)
    v_mfma_f32_32x32x16_bf16 v[40:55], v[28:31], v[84:87], v[40:55]
    ds_read_b64_tr_b16 v[28:29], v6 offset:24576
    ds_read_b64_tr_b16 v[30:31], v6 offset:26624
    s_waitcnt lgkmcnt(7)
    v_mfma_f32_32x32x16_bf16 v[40:55], v[32:35], v[88:91], v[40:55]
    ds_read_b64_tr_b16 v[32:33], v7 offset:24576
    ds_read_b64_tr_b16 v[34:35], v7 offset:26624
    s_waitcnt lgkmcnt(8)
    v_mfma_f32_32x32x16_bf16 v[40:55], v[36:39], v[92:95], v[40:55]
    ds_read_b64_tr_b16 v[36:37], v8 offset:24576
    ds_read_b64_tr_b16 v[38:39], v8 offset:26624
    s_waitcnt lgkmcnt(9)
    v_mfma_f32_32x32x16_bf16 v[40:55], v[16:19], v[96:99], v[40:55]
    ds_read_b64_tr_b16 v[16:17], v5 offset:28672
    ds_read_b64_tr_b16 v[18:19], v5 offset:30720
    s_waitcnt lgkmcnt(10)
    v_mfma_f32_32x32x16_bf16 v[40:55], v[20:23], v[100:103], v[40:55]
    s_nop 11
    v_max3_f32 v13, v40, v41, v42
    v_max3_f32 v14, v43, v44, v45
    v_max3_f32 v13, v13, v46, v47
    v_max3_f32 v14, v14, v48, v49
    v_max3_f32 v13, v13, v50, v51
    v_max3_f32 v14, v14, v52, v53
    v_max3_f32 v13, v13, v54, v55
    v_max_f32 v13, v13, v14
    v_cmp_lt_f32 vcc, s29, v13
    s_cbranch_vccz norescale_26
    v_mov_b32 v14, v13
    s_nop 1
    v_permlane32_swap_b32 v13, v14
    v_max_f32 v13, v13, v14
    v_max_f32 v13, 0, v13
    v_sub_f32 v14, 0, v13
    v_exp_f32 v14, v14
    v_sub_f32 v56, v56, v13
    v_sub_f32 v57, v57, v13
    v_sub_f32 v58, v58, v13
    v_sub_f32 v59, v59, v13
    v_sub_f32 v60, v60, v13
    v_sub_f32 v61, v61, v13
    v_sub_f32 v62, v62, v13
    v_sub_f32 v63, v63, v13
    v_sub_f32 v64, v64, v13
    v_sub_f32 v65, v65, v13
    v_sub_f32 v66, v66, v13
    v_sub_f32 v67, v67, v13
    v_sub_f32 v68, v68, v13
    v_sub_f32 v69, v69, v13
    v_sub_f32 v70, v70, v13
    v_sub_f32 v71, v71, v13
    v_mul_f32 v11, v11, v14
    v_mul_f32 v104, v104, v14
    v_mul_f32 v105, v105, v14
    v_mul_f32 v106, v106, v14
    v_mul_f32 v107, v107, v14
    v_mul_f32 v108, v108, v14
    v_mul_f32 v109, v109, v14
    v_mul_f32 v110, v110, v14
    v_mul_f32 v111, v111, v14
    v_mul_f32 v112, v112, v14
    v_mul_f32 v113, v113, v14
    v_mul_f32 v114, v114, v14
    v_mul_f32 v115, v115, v14
    v_mul_f32 v116, v116, v14
    v_mul_f32 v117, v117, v14
    v_mul_f32 v118, v118, v14
    v_mul_f32 v119, v119, v14
    v_mul_f32 v120, v120, v14
    v_mul_f32 v121, v121, v14
    v_mul_f32 v122, v122, v14
    v_mul_f32 v123, v123, v14
    v_mul_f32 v124, v124, v14
    v_mul_f32 v125, v125, v14
    v_mul_f32 v126, v126, v14
    v_mul_f32 v127, v127, v14
    v_mul_f32 v128, v128, v14
    v_mul_f32 v129, v129, v14
    v_mul_f32 v130, v130, v14
    v_mul_f32 v131, v131, v14
    v_mul_f32 v132, v132, v14
    v_mul_f32 v133, v133, v14
    v_mul_f32 v134, v134, v14
    v_mul_f32 v135, v135, v14
    v_mul_f32 v136, v136, v14
    v_mul_f32 v137, v137, v14
    v_mul_f32 v138, v138, v14
    v_mul_f32 v139, v139, v14
    v_mul_f32 v140, v140, v14
    v_mul_f32 v141, v141, v14
    v_mul_f32 v142, v142, v14
    v_mul_f32 v143, v143, v14
    v_mul_f32 v144, v144, v14
    v_mul_f32 v145, v145, v14
    v_mul_f32 v146, v146, v14
    v_mul_f32 v147, v147, v14
    v_mul_f32 v148, v148, v14
    v_mul_f32 v149, v149, v14
    v_mul_f32 v150, v150, v14
    v_mul_f32 v151, v151, v14
    v_mul_f32 v152, v152, v14
    v_mul_f32 v153, v153, v14
    v_mul_f32 v154, v154, v14
    v_mul_f32 v155, v155, v14
    v_mul_f32 v156, v156, v14
    v_mul_f32 v157, v157, v14
    v_mul_f32 v158, v158, v14
    v_mul_f32 v159, v159, v14
    v_mul_f32 v160, v160, v14
    v_mul_f32 v161, v161, v14
    v_mul_f32 v162, v162, v14
    v_mul_f32 v163, v163, v14
    v_mul_f32 v164, v164, v14
    v_mul_f32 v165, v165, v14
    v_mul_f32 v166, v166, v14
    v_mul_f32 v167, v167, v14
    v_sub_f32 v40, v40, v13
    v_sub_f32 v41, v41, v13
    v_sub_f32 v42, v42, v13
    v_sub_f32 v43, v43, v13
    v_sub_f32 v44, v44, v13
    v_sub_f32 v45, v45, v13
    v_sub_f32 v46, v46, v13
    v_sub_f32 v47, v47, v13
    v_sub_f32 v48, v48, v13
    v_sub_f32 v49, v49, v13
    v_sub_f32 v50, v50, v13
    v_sub_f32 v51, v51, v13
    v_sub_f32 v52, v52, v13
    v_sub_f32 v53, v53, v13
    v_sub_f32 v54, v54, v13
    v_sub_f32 v55, v55, v13
norescale_26:
    v_exp_f32 v40, v40
    v_exp_f32 v41, v41
    v_exp_f32 v42, v42
    v_exp_f32 v43, v43
    v_exp_f32 v44, v44
    v_exp_f32 v45, v45
    v_exp_f32 v46, v46
    v_exp_f32 v47, v47
    v_exp_f32 v48, v48
    v_exp_f32 v49, v49
    v_exp_f32 v50, v50
    v_exp_f32 v51, v51
    v_exp_f32 v52, v52
    v_exp_f32 v53, v53
    v_exp_f32 v54, v54
    v_exp_f32 v55, v55
    s_nop 0
    v_cvt_pk_bf16_f32 v40, v40, v41
    v_cvt_pk_bf16_f32 v41, v42, v43
    v_cvt_pk_bf16_f32 v42, v44, v45
    v_cvt_pk_bf16_f32 v43, v46, v47
    v_cvt_pk_bf16_f32 v44, v48, v49
    v_cvt_pk_bf16_f32 v45, v50, v51
    v_cvt_pk_bf16_f32 v46, v52, v53
    v_cvt_pk_bf16_f32 v47, v54, v55
    v_dot2c_f32_bf16 v11, s37, v40
    v_dot2c_f32_bf16 v11, s37, v41
    v_dot2c_f32_bf16 v11, s37, v42
    v_dot2c_f32_bf16 v11, s37, v43
    v_dot2c_f32_bf16 v11, s37, v44
    v_dot2c_f32_bf16 v11, s37, v45
    v_dot2c_f32_bf16 v11, s37, v46
    v_dot2c_f32_bf16 v11, s37, v47
    ds_read_b64_tr_b16 v[20:21], v6 offset:28672
    ds_read_b64_tr_b16 v[22:23], v6 offset:30720
    s_waitcnt lgkmcnt(10)
    v_mfma_f32_32x32x16_bf16 v[104:119], v[24:27], v[40:43], v[104:119]
    ds_read_b64_tr_b16 v[24:25], v7 offset:28672
    ds_read_b64_tr_b16 v[26:27], v7 offset:30720
    s_waitcnt lgkmcnt(10)
    v_mfma_f32_32x32x16_bf16 v[120:135], v[28:31], v[40:43], v[120:135]
    ds_read_b64_tr_b16 v[28:29], v8 offset:28672
    ds_read_b64_tr_b16 v[30:31], v8 offset:30720
    s_waitcnt lgkmcnt(10)
    v_mfma_f32_32x32x16_bf16 v[136:151], v[32:35], v[40:43], v[136:151]
    s_waitcnt lgkmcnt(8)
    v_mfma_f32_32x32x16_bf16 v[152:167], v[36:39], v[40:43], v[152:167]
    s_waitcnt lgkmcnt(6)
    v_mfma_f32_32x32x16_bf16 v[104:119], v[16:19], v[44:47], v[104:119]
    s_waitcnt lgkmcnt(4)
    v_mfma_f32_32x32x16_bf16 v[120:135], v[20:23], v[44:47], v[120:135]
    s_waitcnt lgkmcnt(2)
    v_mfma_f32_32x32x16_bf16 v[136:151], v[24:27], v[44:47], v[136:151]
    s_waitcnt lgkmcnt(0)
    v_mfma_f32_32x32x16_bf16 v[152:167], v[28:31], v[44:47], v[152:167]
    s_waitcnt vmcnt(8)
    s_barrier
    s_cmp_gt_u32 s4, 3
    s_cbranch_scc1 nodma_27
    s_add_u32 m0, s24, 16384
    s_nop 0
    buffer_load_dwordx4 v1, s[16:19], s26 offen offset:0 nt lds
    buffer_load_dwordx4 v2, s[16:19], s26 offen offset:1024 nt lds
    buffer_load_dwordx4 v3, s[16:19], s26 offen offset:2048 nt lds
    buffer_load_dwordx4 v4, s[16:19], s26 offen offset:3072 nt lds
nodma_27:
    s_add_u32 s26, s26, 8192
    s_and_b32 s26, s26, 0x3ffff
    ds_read_b128 v[16:19], v9 offset:32768
    v_xor_b32 v15, 16, v9
    ds_read_b128 v[20:23], v15 offset:32768
    v_xor_b32 v15, 32, v9
    ds_read_b128 v[24:27], v15 offset:32768
    v_xor_b32 v15, 48, v9
    ds_read_b128 v[28:31], v15 offset:32768
    v_xor_b32 v15, 64, v9
    ds_read_b128 v[32:35], v15 offset:32768
    v_xor_b32 v15, 80, v9
    ds_read_b128 v[36:39], v15 offset:32768
    s_waitcnt lgkmcnt(5)
    v_mfma_f32_32x32x16_bf16 v[40:55], v[16:19], v[72:75], v[56:71]
    v_xor_b32 v15, 96, v9
    ds_read_b128 v[16:19], v15 offset:32768
    s_waitcnt lgkmcnt(5)
    v_mfma_f32_32x32x16_bf16 v[40:55], v[20:23], v[76:79], v[40:55]
    v_xor_b32 v15, 112, v9
    ds_read_b128 v[20:23], v15 offset:32768
    s_waitcnt lgkmcnt(5)
    v_mfma_f32_32x32x16_bf16 v[40:55], v[24:27], v[80:83], v[40:55]
    ds_read_b64_tr_b16 v[24:25], v5 offset:40960
    ds_read_b64_tr_b16 v[26:27], v5 offset:43008
    s_waitcnt lgkmcnt(6)
    v_mfma_f32_32x32x16_bf16 v[40:55], v[28:31], v[84:87], v[40:55]
    ds_read_b64_tr_b16 v[28:29], v6 offset:40960
    ds_read_b64_tr_b16 v[30:31], v6 offset:43008
    s_waitcnt lgkmcnt(7)
    v_mfma_f32_32x32x16_bf16 v[40:55], v[32:35], v[88:91], v[40:55]
    ds_read_b64_tr_b16 v[32:33], v7 offset:40960
    ds_read_b64_tr_b16 v[34:35], v7 offset:43008
    s_waitcnt lgkmcnt(8)
    v_mfma_f32_32x32x16_bf16 v[40:55], v[36:39], v[92:95], v[40:55]
    ds_read_b64_tr_b16 v[36:37], v8 offset:40960
    ds_read_b64_tr_b16 v[38:39], v8 offset:43008
    s_waitcnt lgkmcnt(9)
    v_mfma_f32_32x32x16_bf16 v[40:55], v[16:19], v[96:99], v[40:55]
    ds_read_b64_tr_b16 v[16:17], v5 offset:45056
    ds_read_b64_tr_b16 v[18:19], v5 offset:47104
    s_waitcnt lgkmcnt(10)
    v_mfma_f32_32x32x16_bf16 v[40:55], v[20:23], v[100:103], v[40:55]
    s_nop 11
    v_max3_f32 v13, v40, v41, v42
    v_max3_f32 v14, v43, v44, v45
    v_max3_f32 v13, v13, v46, v47
    v_max3_f32 v14, v14, v48, v49
    v_max3_f32 v13, v13, v50, v51
    v_max3_f32 v14, v14, v52, v53
    v_max3_f32 v13, v13, v54, v55
    v_max_f32 v13, v13, v14
    v_cmp_lt_f32 vcc, s29, v13
    s_cbranch_vccz norescale_28
    v_mov_b32 v14, v13
    s_nop 1
    v_permlane32_swap_b32 v13, v14
    v_max_f32 v13, v13, v14
    v_max_f32 v13, 0, v13
    v_sub_f32 v14, 0, v13
    v_exp_f32 v14, v14
    v_sub_f32 v56, v56, v13
    v_sub_f32 v57, v57, v13
    v_sub_f32 v58, v58, v13
    v_sub_f32 v59, v59, v13
    v_sub_f32 v60, v60, v13
    v_sub_f32 v61, v61, v13
    v_sub_f32 v62, v62, v13
    v_sub_f32 v63, v63, v13
    v_sub_f32 v64, v64, v13
    v_sub_f32 v65, v65, v13
    v_sub_f32 v66, v66, v13
    v_sub_f32 v67, v67, v13
    v_sub_f32 v68, v68, v13
    v_sub_f32 v69, v69, v13
    v_sub_f32 v70, v70, v13
    v_sub_f32 v71, v71, v13
    v_mul_f32 v11, v11, v14
    v_mul_f32 v104, v104, v14
    v_mul_f32 v105, v105, v14
    v_mul_f32 v106, v106, v14
    v_mul_f32 v107, v107, v14
    v_mul_f32 v108, v108, v14
    v_mul_f32 v109, v109, v14
    v_mul_f32 v110, v110, v14
    v_mul_f32 v111, v111, v14
    v_mul_f32 v112, v112, v14
    v_mul_f32 v113, v113, v14
    v_mul_f32 v114, v114, v14
    v_mul_f32 v115, v115, v14
    v_mul_f32 v116, v116, v14
    v_mul_f32 v117, v117, v14
    v_mul_f32 v118, v118, v14
    v_mul_f32 v119, v119, v14
    v_mul_f32 v120, v120, v14
    v_mul_f32 v121, v121, v14
    v_mul_f32 v122, v122, v14
    v_mul_f32 v123, v123, v14
    v_mul_f32 v124, v124, v14
    v_mul_f32 v125, v125, v14
    v_mul_f32 v126, v126, v14
    v_mul_f32 v127, v127, v14
    v_mul_f32 v128, v128, v14
    v_mul_f32 v129, v129, v14
    v_mul_f32 v130, v130, v14
    v_mul_f32 v131, v131, v14
    v_mul_f32 v132, v132, v14
    v_mul_f32 v133, v133, v14
    v_mul_f32 v134, v134, v14
    v_mul_f32 v135, v135, v14
    v_mul_f32 v136, v136, v14
    v_mul_f32 v137, v137, v14
    v_mul_f32 v138, v138, v14
    v_mul_f32 v139, v139, v14
    v_mul_f32 v140, v140, v14
    v_mul_f32 v141, v141, v14
    v_mul_f32 v142, v142, v14
    v_mul_f32 v143, v143, v14
    v_mul_f32 v144, v144, v14
    v_mul_f32 v145, v145, v14
    v_mul_f32 v146, v146, v14
    v_mul_f32 v147, v147, v14
    v_mul_f32 v148, v148, v14
    v_mul_f32 v149, v149, v14
    v_mul_f32 v150, v150, v14
    v_mul_f32 v151, v151, v14
    v_mul_f32 v152, v152, v14
    v_mul_f32 v153, v153, v14
    v_mul_f32 v154, v154, v14
    v_mul_f32 v155, v155, v14
    v_mul_f32 v156, v156, v14
    v_mul_f32 v157, v157, v14
    v_mul_f32 v158, v158, v14
    v_mul_f32 v159, v159, v14
    v_mul_f32 v160, v160, v14
    v_mul_f32 v161, v161, v14
    v_mul_f32 v162, v162, v14
    v_mul_f32 v163, v163, v14
    v_mul_f32 v164, v164, v14
    v_mul_f32 v165, v165, v14
    v_mul_f32 v166, v166, v14
    v_mul_f32 v167, v167, v14
    v_sub_f32 v40, v40, v13
    v_sub_f32 v41, v41, v13
    v_sub_f32 v42, v42, v13
    v_sub_f32 v43, v43, v13
    v_sub_f32 v44, v44, v13
    v_sub_f32 v45, v45, v13
    v_sub_f32 v46, v46, v13
    v_sub_f32 v47, v47, v13
    v_sub_f32 v48, v48, v13
    v_sub_f32 v49, v49, v13
    v_sub_f32 v50, v50, v13
    v_sub_f32 v51, v51, v13
    v_sub_f32 v52, v52, v13
    v_sub_f32 v53, v53, v13
    v_sub_f32 v54, v54, v13
    v_sub_f32 v55, v55, v13
norescale_28:
    v_exp_f32 v40, v40
    v_exp_f32 v41, v41
    v_exp_f32 v42, v42
    v_exp_f32 v43, v43
    v_exp_f32 v44, v44
    v_exp_f32 v45, v45
    v_exp_f32 v46, v46
    v_exp_f32 v47, v47
    v_exp_f32 v48, v48
    v_exp_f32 v49, v49
    v_exp_f32 v50, v50
    v_exp_f32 v51, v51
    v_exp_f32 v52, v52
    v_exp_f32 v53, v53
    v_exp_f32 v54, v54
    v_exp_f32 v55, v55
    s_nop 0
    v_cvt_pk_bf16_f32 v40, v40, v41
    v_cvt_pk_bf16_f32 v41, v42, v43
    v_cvt_pk_bf16_f32 v42, v44, v45
    v_cvt_pk_bf16_f32 v43, v46, v47
    v_cvt_pk_bf16_f32 v44, v48, v49
    v_cvt_pk_bf16_f32 v45, v50, v51
    v_cvt_pk_bf16_f32 v46, v52, v53
    v_cvt_pk_bf16_f32 v47, v54, v55
    v_dot2c_f32_bf16 v11, s37, v40
    v_dot2c_f32_bf16 v11, s37, v41
    v_dot2c_f32_bf16 v11, s37, v42
    v_dot2c_f32_bf16 v11, s37, v43
    v_dot2c_f32_bf16 v11, s37, v44
    v_dot2c_f32_bf16 v11, s37, v45
    v_dot2c_f32_bf16 v11, s37, v46
    v_dot2c_f32_bf16 v11, s37, v47
    ds_read_b64_tr_b16 v[20:21], v6 offset:45056
    ds_read_b64_tr_b16 v[22:23], v6 offset:47104
    s_waitcnt lgkmcnt(10)
    v_mfma_f32_32x32x16_bf16 v[104:119], v[24:27], v[40:43], v[104:119]
    ds_read_b64_tr_b16 v[24:25], v7 offset:45056
    ds_read_b64_tr_b16 v[26:27], v7 offset:47104
    s_waitcnt lgkmcnt(10)
    v_mfma_f32_32x32x16_bf16 v[120:135], v[28:31], v[40:43], v[120:135]
    ds_read_b64_tr_b16 v[28:29], v8 offset:45056
    ds_read_b64_tr_b16 v[30:31], v8 offset:47104
    s_waitcnt lgkmcnt(10)
    v_mfma_f32_32x32x16_bf16 v[136:151], v[32:35], v[40:43], v[136:151]
    s_waitcnt lgkmcnt(8)
    v_mfma_f32_32x32x16_bf16 v[152:167], v[36:39], v[40:43], v[152:167]
    s_waitcnt lgkmcnt(6)
    v_mfma_f32_32x32x16_bf16 v[104:119], v[16:19], v[44:47], v[104:119]
    s_waitcnt lgkmcnt(4)
    v_mfma_f32_32x32x16_bf16 v[120:135], v[20:23], v[44:47], v[120:135]
    s_waitcnt lgkmcnt(2)
    v_mfma_f32_32x32x16_bf16 v[136:151], v[24:27], v[44:47], v[136:151]
    s_waitcnt lgkmcnt(0)
    v_mfma_f32_32x32x16_bf16 v[152:167], v[28:31], v[44:47], v[152:167]
    s_waitcnt vmcnt(8)
    s_barrier
    s_cmp_gt_u32 s4, 3
    s_cbranch_scc1 nodma_29
    s_add_u32 m0, s24, 32768
    s_nop 0
    buffer_load_dwordx4 v1, s[16:19], s26 offen offset:0 nt lds
    buffer_load_dwordx4 v2, s[16:19], s26 offen offset:1024 nt lds
    buffer_load_dwordx4 v3, s[16:19], s26 offen offset:2048 nt lds
    buffer_load_dwordx4 v4, s[16:19], s26 offen offset:3072 nt lds
nodma_29:
    s_add_u32 s26, s26, 8192
    s_and_b32 s26, s26, 0x3ffff
    ds_read_b128 v[16:19], v9 offset:49152
    v_xor_b32 v15, 16, v9
    ds_read_b128 v[20:23], v15 offset:49152
    v_xor_b32 v15, 32, v9
    ds_read_b128 v[24:27], v15 offset:49152
    v_xor_b32 v15, 48, v9
    ds_read_b128 v[28:31], v15 offset:49152
    v_xor_b32 v15, 64, v9
    ds_read_b128 v[32:35], v15 offset:49152
    v_xor_b32 v15, 80, v9
    ds_read_b128 v[36:39], v15 offset:49152
    s_waitcnt lgkmcnt(5)
    v_mfma_f32_32x32x16_bf16 v[40:55], v[16:19], v[72:75], v[56:71]
    v_xor_b32 v15, 96, v9
    ds_read_b128 v[16:19], v15 offset:49152
    s_waitcnt lgkmcnt(5)
    v_mfma_f32_32x32x16_bf16 v[40:55], v[20:23], v[76:79], v[40:55]
    v_xor_b32 v15, 112, v9
    ds_read_b128 v[20:23], v15 offset:49152
    s_waitcnt lgkmcnt(5)
    v_mfma_f32_32x32x16_bf16 v[40:55], v[24:27], v[80:83], v[40:55]
    ds_read_b64_tr_b16 v[24:25], v5 offset:57344
    ds_read_b64_tr_b16 v[26:27], v5 offset:59392
    s_waitcnt lgkmcnt(6)
    v_mfma_f32_32x32x16_bf16 v[40:55], v[28:31], v[84:87], v[40:55]
    ds_read_b64_tr_b16 v[28:29], v6 offset:57344
    ds_read_b64_tr_b16 v[30:31], v6 offset:59392
    s_waitcnt lgkmcnt(7)
    v_mfma_f32_32x32x16_bf16 v[40:55], v[32:35], v[88:91], v[40:55]
    ds_read_b64_tr_b16 v[32:33], v7 offset:57344
    ds_read_b64_tr_b16 v[34:35], v7 offset:59392
    s_waitcnt lgkmcnt(8)
    v_mfma_f32_32x32x16_bf16 v[40:55], v[36:39], v[92:95], v[40:55]
    ds_read_b64_tr_b16 v[36:37], v8 offset:57344
    ds_read_b64_tr_b16 v[38:39], v8 offset:59392
    s_waitcnt lgkmcnt(9)
    v_mfma_f32_32x32x16_bf16 v[40:55], v[16:19], v[96:99], v[40:55]
    ds_read_b64_tr_b16 v[16:17], v5 offset:61440
    ds_read_b64_tr_b16 v[18:19], v5 offset:63488
    s_waitcnt lgkmcnt(10)
    v_mfma_f32_32x32x16_bf16 v[40:55], v[20:23], v[100:103], v[40:55]
    s_nop 11
    v_max3_f32 v13, v40, v41, v42
    v_max3_f32 v14, v43, v44, v45
    v_max3_f32 v13, v13, v46, v47
    v_max3_f32 v14, v14, v48, v49
    v_max3_f32 v13, v13, v50, v51
    v_max3_f32 v14, v14, v52, v53
    v_max3_f32 v13, v13, v54, v55
    v_max_f32 v13, v13, v14
    v_cmp_lt_f32 vcc, s29, v13
    s_cbranch_vccz norescale_30
    v_mov_b32 v14, v13
    s_nop 1
    v_permlane32_swap_b32 v13, v14
    v_max_f32 v13, v13, v14
    v_max_f32 v13, 0, v13
    v_sub_f32 v14, 0, v13
    v_exp_f32 v14, v14
    v_sub_f32 v56, v56, v13
    v_sub_f32 v57, v57, v13
    v_sub_f32 v58, v58, v13
    v_sub_f32 v59, v59, v13
    v_sub_f32 v60, v60, v13
    v_sub_f32 v61, v61, v13
    v_sub_f32 v62, v62, v13
    v_sub_f32 v63, v63, v13
    v_sub_f32 v64, v64, v13
    v_sub_f32 v65, v65, v13
    v_sub_f32 v66, v66, v13
    v_sub_f32 v67, v67, v13
    v_sub_f32 v68, v68, v13
    v_sub_f32 v69, v69, v13
    v_sub_f32 v70, v70, v13
    v_sub_f32 v71, v71, v13
    v_mul_f32 v11, v11, v14
    v_mul_f32 v104, v104, v14
    v_mul_f32 v105, v105, v14
    v_mul_f32 v106, v106, v14
    v_mul_f32 v107, v107, v14
    v_mul_f32 v108, v108, v14
    v_mul_f32 v109, v109, v14
    v_mul_f32 v110, v110, v14
    v_mul_f32 v111, v111, v14
    v_mul_f32 v112, v112, v14
    v_mul_f32 v113, v113, v14
    v_mul_f32 v114, v114, v14
    v_mul_f32 v115, v115, v14
    v_mul_f32 v116, v116, v14
    v_mul_f32 v117, v117, v14
    v_mul_f32 v118, v118, v14
    v_mul_f32 v119, v119, v14
    v_mul_f32 v120, v120, v14
    v_mul_f32 v121, v121, v14
    v_mul_f32 v122, v122, v14
    v_mul_f32 v123, v123, v14
    v_mul_f32 v124, v124, v14
    v_mul_f32 v125, v125, v14
    v_mul_f32 v126, v126, v14
    v_mul_f32 v127, v127, v14
    v_mul_f32 v128, v128, v14
    v_mul_f32 v129, v129, v14
    v_mul_f32 v130, v130, v14
    v_mul_f32 v131, v131, v14
    v_mul_f32 v132, v132, v14
    v_mul_f32 v133, v133, v14
    v_mul_f32 v134, v134, v14
    v_mul_f32 v135, v135, v14
    v_mul_f32 v136, v136, v14
    v_mul_f32 v137, v137, v14
    v_mul_f32 v138, v138, v14
    v_mul_f32 v139, v139, v14
    v_mul_f32 v140, v140, v14
    v_mul_f32 v141, v141, v14
    v_mul_f32 v142, v142, v14
    v_mul_f32 v143, v143, v14
    v_mul_f32 v144, v144, v14
    v_mul_f32 v145, v145, v14
    v_mul_f32 v146, v146, v14
    v_mul_f32 v147, v147, v14
    v_mul_f32 v148, v148, v14
    v_mul_f32 v149, v149, v14
    v_mul_f32 v150, v150, v14
    v_mul_f32 v151, v151, v14
    v_mul_f32 v152, v152, v14
    v_mul_f32 v153, v153, v14
    v_mul_f32 v154, v154, v14
    v_mul_f32 v155, v155, v14
    v_mul_f32 v156, v156, v14
    v_mul_f32 v157, v157, v14
    v_mul_f32 v158, v158, v14
    v_mul_f32 v159, v159, v14
    v_mul_f32 v160, v160, v14
    v_mul_f32 v161, v161, v14
    v_mul_f32 v162, v162, v14
    v_mul_f32 v163, v163, v14
    v_mul_f32 v164, v164, v14
    v_mul_f32 v165, v165, v14
    v_mul_f32 v166, v166, v14
    v_mul_f32 v167, v167, v14
    v_sub_f32 v40, v40, v13
    v_sub_f32 v41, v41, v13
    v_sub_f32 v42, v42, v13
    v_sub_f32 v43, v43, v13
    v_sub_f32 v44, v44, v13
    v_sub_f32 v45, v45, v13
    v_sub_f32 v46, v46, v13
    v_sub_f32 v47, v47, v13
    v_sub_f32 v48, v48, v13
    v_sub_f32 v49, v49, v13
    v_sub_f32 v50, v50, v13
    v_sub_f32 v51, v51, v13
    v_sub_f32 v52, v52, v13
    v_sub_f32 v53, v53, v13
    v_sub_f32 v54, v54, v13
    v_sub_f32 v55, v55, v13
norescale_30:
    v_exp_f32 v40, v40
    v_exp_f32 v41, v41
    v_exp_f32 v42, v42
    v_exp_f32 v43, v43
    v_exp_f32 v44, v44
    v_exp_f32 v45, v45
    v_exp_f32 v46, v46
    v_exp_f32 v47, v47
    v_exp_f32 v48, v48
    v_exp_f32 v49, v49
    v_exp_f32 v50, v50
    v_exp_f32 v51, v51
    v_exp_f32 v52, v52
    v_exp_f32 v53, v53
    v_exp_f32 v54, v54
    v_exp_f32 v55, v55
    s_nop 0
    v_cvt_pk_bf16_f32 v40, v40, v41
    v_cvt_pk_bf16_f32 v41, v42, v43
    v_cvt_pk_bf16_f32 v42, v44, v45
    v_cvt_pk_bf16_f32 v43, v46, v47
    v_cvt_pk_bf16_f32 v44, v48, v49
    v_cvt_pk_bf16_f32 v45, v50, v51
    v_cvt_pk_bf16_f32 v46, v52, v53
    v_cvt_pk_bf16_f32 v47, v54, v55
    v_dot2c_f32_bf16 v11, s37, v40
    v_dot2c_f32_bf16 v11, s37, v41
    v_dot2c_f32_bf16 v11, s37, v42
    v_dot2c_f32_bf16 v11, s37, v43
    v_dot2c_f32_bf16 v11, s37, v44
    v_dot2c_f32_bf16 v11, s37, v45
    v_dot2c_f32_bf16 v11, s37, v46
    v_dot2c_f32_bf16 v11, s37, v47
    ds_read_b64_tr_b16 v[20:21], v6 offset:61440
    ds_read_b64_tr_b16 v[22:23], v6 offset:63488
    s_waitcnt lgkmcnt(10)
    v_mfma_f32_32x32x16_bf16 v[104:119], v[24:27], v[40:43], v[104:119]
    ds_read_b64_tr_b16 v[24:25], v7 offset:61440
    ds_read_b64_tr_b16 v[26:27], v7 offset:63488
    s_waitcnt lgkmcnt(10)
    v_mfma_f32_32x32x16_bf16 v[120:135], v[28:31], v[40:43], v[120:135]
    ds_read_b64_tr_b16 v[28:29], v8 offset:61440
    ds_read_b64_tr_b16 v[30:31], v8 offset:63488
    s_waitcnt lgkmcnt(10)
    v_mfma_f32_32x32x16_bf16 v[136:151], v[32:35], v[40:43], v[136:151]
    s_waitcnt lgkmcnt(8)
    v_mfma_f32_32x32x16_bf16 v[152:167], v[36:39], v[40:43], v[152:167]
    s_waitcnt lgkmcnt(6)
    v_mfma_f32_32x32x16_bf16 v[104:119], v[16:19], v[44:47], v[104:119]
    s_waitcnt lgkmcnt(4)
    v_mfma_f32_32x32x16_bf16 v[120:135], v[20:23], v[44:47], v[120:135]
    s_waitcnt lgkmcnt(2)
    v_mfma_f32_32x32x16_bf16 v[136:151], v[24:27], v[44:47], v[136:151]
    s_waitcnt lgkmcnt(0)
    v_mfma_f32_32x32x16_bf16 v[152:167], v[28:31], v[44:47], v[152:167]
    s_waitcnt vmcnt(8)
    s_barrier
    s_cmp_gt_u32 s4, 3
    s_cbranch_scc1 nodma_31
    s_add_u32 m0, s24, 49152
    s_nop 0
    buffer_load_dwordx4 v1, s[16:19], s26 offen offset:0 nt lds
    buffer_load_dwordx4 v2, s[16:19], s26 offen offset:1024 nt lds
    buffer_load_dwordx4 v3, s[16:19], s26 offen offset:2048 nt lds
    buffer_load_dwordx4 v4, s[16:19], s26 offen offset:3072 nt lds
nodma_31:
    s_add_u32 s26, s26, 8192
    s_and_b32 s26, s26, 0x3ffff
    ds_read_b128 v[16:19], v9 offset:0
    v_xor_b32 v15, 16, v9
    ds_read_b128 v[20:23], v15 offset:0
    v_xor_b32 v15, 32, v9
    ds_read_b128 v[24:27], v15 offset:0
    v_xor_b32 v15, 48, v9
    ds_read_b128 v[28:31], v15 offset:0
    v_xor_b32 v15, 64, v9
    ds_read_b128 v[32:35], v15 offset:0
    v_xor_b32 v15, 80, v9
    ds_read_b128 v[36:39], v15 offset:0
    s_waitcnt lgkmcnt(5)
    v_mfma_f32_32x32x16_bf16 v[40:55], v[16:19], v[72:75], v[56:71]
    v_xor_b32 v15, 96, v9
    ds_read_b128 v[16:19], v15 offset:0
    s_waitcnt lgkmcnt(5)
    v_mfma_f32_32x32x16_bf16 v[40:55], v[20:23], v[76:79], v[40:55]
    v_xor_b32 v15, 112, v9
    ds_read_b128 v[20:23], v15 offset:0
    s_waitcnt lgkmcnt(5)
    v_mfma_f32_32x32x16_bf16 v[40:55], v[24:27], v[80:83], v[40:55]
    ds_read_b64_tr_b16 v[24:25], v5 offset:8192
    ds_read_b64_tr_b16 v[26:27], v5 offset:10240
    s_waitcnt lgkmcnt(6)
    v_mfma_f32_32x32x16_bf16 v[40:55], v[28:31], v[84:87], v[40:55]
    ds_read_b64_tr_b16 v[28:29], v6 offset:8192
    ds_read_b64_tr_b16 v[30:31], v6 offset:10240
    s_waitcnt lgkmcnt(7)
    v_mfma_f32_32x32x16_bf16 v[40:55], v[32:35], v[88:91], v[40:55]
    ds_read_b64_tr_b16 v[32:33], v7 offset:8192
    ds_read_b64_tr_b16 v[34:35], v7 offset:10240
    s_waitcnt lgkmcnt(8)
    v_mfma_f32_32x32x16_bf16 v[40:55], v[36:39], v[92:95], v[40:55]
    ds_read_b64_tr_b16 v[36:37], v8 offset:8192
    ds_read_b64_tr_b16 v[38:39], v8 offset:10240
    s_waitcnt lgkmcnt(9)
    v_mfma_f32_32x32x16_bf16 v[40:55], v[16:19], v[96:99], v[40:55]
    ds_read_b64_tr_b16 v[16:17], v5 offset:12288
    ds_read_b64_tr_b16 v[18:19], v5 offset:14336
    s_waitcnt lgkmcnt(10)
    v_mfma_f32_32x32x16_bf16 v[40:55], v[20:23], v[100:103], v[40:55]
    s_nop 11
    v_max3_f32 v13, v40, v41, v42
    v_max3_f32 v14, v43, v44, v45
    v_max3_f32 v13, v13, v46, v47
    v_max3_f32 v14, v14, v48, v49
    v_max3_f32 v13, v13, v50, v51
    v_max3_f32 v14, v14, v52, v53
    v_max3_f32 v13, v13, v54, v55
    v_max_f32 v13, v13, v14
    v_cmp_lt_f32 vcc, s29, v13
    s_cbranch_vccz norescale_32
    v_mov_b32 v14, v13
    s_nop 1
    v_permlane32_swap_b32 v13, v14
    v_max_f32 v13, v13, v14
    v_max_f32 v13, 0, v13
    v_sub_f32 v14, 0, v13
    v_exp_f32 v14, v14
    v_sub_f32 v56, v56, v13
    v_sub_f32 v57, v57, v13
    v_sub_f32 v58, v58, v13
    v_sub_f32 v59, v59, v13
    v_sub_f32 v60, v60, v13
    v_sub_f32 v61, v61, v13
    v_sub_f32 v62, v62, v13
    v_sub_f32 v63, v63, v13
    v_sub_f32 v64, v64, v13
    v_sub_f32 v65, v65, v13
    v_sub_f32 v66, v66, v13
    v_sub_f32 v67, v67, v13
    v_sub_f32 v68, v68, v13
    v_sub_f32 v69, v69, v13
    v_sub_f32 v70, v70, v13
    v_sub_f32 v71, v71, v13
    v_mul_f32 v11, v11, v14
    v_mul_f32 v104, v104, v14
    v_mul_f32 v105, v105, v14
    v_mul_f32 v106, v106, v14
    v_mul_f32 v107, v107, v14
    v_mul_f32 v108, v108, v14
    v_mul_f32 v109, v109, v14
    v_mul_f32 v110, v110, v14
    v_mul_f32 v111, v111, v14
    v_mul_f32 v112, v112, v14
    v_mul_f32 v113, v113, v14
    v_mul_f32 v114, v114, v14
    v_mul_f32 v115, v115, v14
    v_mul_f32 v116, v116, v14
    v_mul_f32 v117, v117, v14
    v_mul_f32 v118, v118, v14
    v_mul_f32 v119, v119, v14
    v_mul_f32 v120, v120, v14
    v_mul_f32 v121, v121, v14
    v_mul_f32 v122, v122, v14
    v_mul_f32 v123, v123, v14
    v_mul_f32 v124, v124, v14
    v_mul_f32 v125, v125, v14
    v_mul_f32 v126, v126, v14
    v_mul_f32 v127, v127, v14
    v_mul_f32 v128, v128, v14
    v_mul_f32 v129, v129, v14
    v_mul_f32 v130, v130, v14
    v_mul_f32 v131, v131, v14
    v_mul_f32 v132, v132, v14
    v_mul_f32 v133, v133, v14
    v_mul_f32 v134, v134, v14
    v_mul_f32 v135, v135, v14
    v_mul_f32 v136, v136, v14
    v_mul_f32 v137, v137, v14
    v_mul_f32 v138, v138, v14
    v_mul_f32 v139, v139, v14
    v_mul_f32 v140, v140, v14
    v_mul_f32 v141, v141, v14
    v_mul_f32 v142, v142, v14
    v_mul_f32 v143, v143, v14
    v_mul_f32 v144, v144, v14
    v_mul_f32 v145, v145, v14
    v_mul_f32 v146, v146, v14
    v_mul_f32 v147, v147, v14
    v_mul_f32 v148, v148, v14
    v_mul_f32 v149, v149, v14
    v_mul_f32 v150, v150, v14
    v_mul_f32 v151, v151, v14
    v_mul_f32 v152, v152, v14
    v_mul_f32 v153, v153, v14
    v_mul_f32 v154, v154, v14
    v_mul_f32 v155, v155, v14
    v_mul_f32 v156, v156, v14
    v_mul_f32 v157, v157, v14
    v_mul_f32 v158, v158, v14
    v_mul_f32 v159, v159, v14
    v_mul_f32 v160, v160, v14
    v_mul_f32 v161, v161, v14
    v_mul_f32 v162, v162, v14
    v_mul_f32 v163, v163, v14
    v_mul_f32 v164, v164, v14
    v_mul_f32 v165, v165, v14
    v_mul_f32 v166, v166, v14
    v_mul_f32 v167, v167, v14
    v_sub_f32 v40, v40, v13
    v_sub_f32 v41, v41, v13
    v_sub_f32 v42, v42, v13
    v_sub_f32 v43, v43, v13
    v_sub_f32 v44, v44, v13
    v_sub_f32 v45, v45, v13
    v_sub_f32 v46, v46, v13
    v_sub_f32 v47, v47, v13
    v_sub_f32 v48, v48, v13
    v_sub_f32 v49, v49, v13
    v_sub_f32 v50, v50, v13
    v_sub_f32 v51, v51, v13
    v_sub_f32 v52, v52, v13
    v_sub_f32 v53, v53, v13
    v_sub_f32 v54, v54, v13
    v_sub_f32 v55, v55, v13
norescale_32:
    v_exp_f32 v40, v40
    v_exp_f32 v41, v41
    v_exp_f32 v42, v42
    v_exp_f32 v43, v43
    v_exp_f32 v44, v44
    v_exp_f32 v45, v45
    v_exp_f32 v46, v46
    v_exp_f32 v47, v47
    v_exp_f32 v48, v48
    v_exp_f32 v49, v49
    v_exp_f32 v50, v50
    v_exp_f32 v51, v51
    v_exp_f32 v52, v52
    v_exp_f32 v53, v53
    v_exp_f32 v54, v54
    v_exp_f32 v55, v55
    s_nop 0
    v_cvt_pk_bf16_f32 v40, v40, v41
    v_cvt_pk_bf16_f32 v41, v42, v43
    v_cvt_pk_bf16_f32 v42, v44, v45
    v_cvt_pk_bf16_f32 v43, v46, v47
    v_cvt_pk_bf16_f32 v44, v48, v49
    v_cvt_pk_bf16_f32 v45, v50, v51
    v_cvt_pk_bf16_f32 v46, v52, v53
    v_cvt_pk_bf16_f32 v47, v54, v55
    v_dot2c_f32_bf16 v11, s37, v40
    v_dot2c_f32_bf16 v11, s37, v41
    v_dot2c_f32_bf16 v11, s37, v42
    v_dot2c_f32_bf16 v11, s37, v43
    v_dot2c_f32_bf16 v11, s37, v44
    v_dot2c_f32_bf16 v11, s37, v45
    v_dot2c_f32_bf16 v11, s37, v46
    v_dot2c_f32_bf16 v11, s37, v47
    ds_read_b64_tr_b16 v[20:21], v6 offset:12288
    ds_read_b64_tr_b16 v[22:23], v6 offset:14336
    s_waitcnt lgkmcnt(10)
    v_mfma_f32_32x32x16_bf16 v[104:119], v[24:27], v[40:43], v[104:119]
    ds_read_b64_tr_b16 v[24:25], v7 offset:12288
    ds_read_b64_tr_b16 v[26:27], v7 offset:14336
    s_waitcnt lgkmcnt(10)
    v_mfma_f32_32x32x16_bf16 v[120:135], v[28:31], v[40:43], v[120:135]
    ds_read_b64_tr_b16 v[28:29], v8 offset:12288
    ds_read_b64_tr_b16 v[30:31], v8 offset:14336
    s_waitcnt lgkmcnt(10)
    v_mfma_f32_32x32x16_bf16 v[136:151], v[32:35], v[40:43], v[136:151]
    s_waitcnt lgkmcnt(8)
    v_mfma_f32_32x32x16_bf16 v[152:167], v[36:39], v[40:43], v[152:167]
    s_waitcnt lgkmcnt(6)
    v_mfma_f32_32x32x16_bf16 v[104:119], v[16:19], v[44:47], v[104:119]
    s_waitcnt lgkmcnt(4)
    v_mfma_f32_32x32x16_bf16 v[120:135], v[20:23], v[44:47], v[120:135]
    s_waitcnt lgkmcnt(2)
    v_mfma_f32_32x32x16_bf16 v[136:151], v[24:27], v[44:47], v[136:151]
    s_waitcnt lgkmcnt(0)
    v_mfma_f32_32x32x16_bf16 v[152:167], v[28:31], v[44:47], v[152:167]
    s_add_u32 s27, s27, 1
    s_cmp_lt_u32 s27, 7
    s_cbranch_scc1 att_loop
    s_cmp_eq_u32 s36, 1
    s_cbranch_scc1 tail_last
    s_waitcnt vmcnt(8)
    s_barrier
    s_cmp_gt_u32 s4, 3
    s_cbranch_scc1 nodma_33
    s_add_u32 m0, s24, 65536
    s_add_u32 s25, s30, 1048576
    buffer_load_dwordx4 v0, s[72:75], s25 offen offset:0 lds
    s_add_u32 s25, s25, 31744
    buffer_load_dwordx4 v0, s[72:75], s25 offen offset:1024 lds
    s_add_u32 s25, s25, 31744
    buffer_load_dwordx4 v0, s[72:75], s25 offen offset:2048 lds
    s_add_u32 s25, s25, 31744
    buffer_load_dwordx4 v0, s[72:75], s25 offen offset:3072 lds
nodma_33:
    s_cmp_gt_u32 s4, 3
    s_cbranch_scc1 nodma_34
    s_add_u32 m0, s24, 0
    s_add_u32 s25, s30, 1572864
    buffer_load_dwordx4 v0, s[72:75], s25 offen offset:0 lds
    s_add_u32 s25, s25, 31744
    buffer_load_dwordx4 v0, s[72:75], s25 offen offset:1024 lds
    s_add_u32 s25, s25, 31744
    buffer_load_dwordx4 v0, s[72:75], s25 offen offset:2048 lds
    s_add_u32 s25, s25, 31744
    buffer_load_dwordx4 v0, s[72:75], s25 offen offset:3072 lds
nodma_34:
    ds_read_b128 v[16:19], v9 offset:16384
    v_xor_b32 v15, 16, v9
    ds_read_b128 v[20:23], v15 offset:16384
    v_xor_b32 v15, 32, v9
    ds_read_b128 v[24:27], v15 offset:16384
    v_xor_b32 v15, 48, v9
    ds_read_b128 v[28:31], v15 offset:16384
    v_xor_b32 v15, 64, v9
    ds_read_b128 v[32:35], v15 offset:16384
    v_xor_b32 v15, 80, v9
    ds_read_b128 v[36:39], v15 offset:16384
    s_waitcnt lgkmcnt(5)
    v_mfma_f32_32x32x16_bf16 v[40:55], v[16:19], v[72:75], v[56:71]
    v_xor_b32 v15, 96, v9
    ds_read_b128 v[16:19], v15 offset:16384
    s_waitcnt lgkmcnt(5)
    v_mfma_f32_32x32x16_bf16 v[40:55], v[20:23], v[76:79], v[40:55]
    v_xor_b32 v15, 112, v9
    ds_read_b128 v[20:23], v15 offset:16384
    s_waitcnt lgkmcnt(5)
    v_mfma_f32_32x32x16_bf16 v[40:55], v[24:27], v[80:83], v[40:55]
    ds_read_b64_tr_b16 v[24:25], v5 offset:24576
    ds_read_b64_tr_b16 v[26:27], v5 offset:26624
    s_waitcnt lgkmcnt(6)
    v_mfma_f32_32x32x16_bf16 v[40:55], v[28:31], v[84:87], v[40:55]
    ds_read_b64_tr_b16 v[28:29], v6 offset:24576
    ds_read_b64_tr_b16 v[30:31], v6 offset:26624
    s_waitcnt lgkmcnt(7)
    v_mfma_f32_32x32x16_bf16 v[40:55], v[32:35], v[88:91], v[40:55]
    ds_read_b64_tr_b16 v[32:33], v7 offset:24576
    ds_read_b64_tr_b16 v[34:35], v7 offset:26624
    s_waitcnt lgkmcnt(8)
    v_mfma_f32_32x32x16_bf16 v[40:55], v[36:39], v[92:95], v[40:55]
    ds_read_b64_tr_b16 v[36:37], v8 offset:24576
    ds_read_b64_tr_b16 v[38:39], v8 offset:26624
    s_waitcnt lgkmcnt(9)
    v_mfma_f32_32x32x16_bf16 v[40:55], v[16:19], v[96:99], v[40:55]
    ds_read_b64_tr_b16 v[16:17], v5 offset:28672
    ds_read_b64_tr_b16 v[18:19], v5 offset:30720
    s_waitcnt lgkmcnt(10)
    v_mfma_f32_32x32x16_bf16 v[40:55], v[20:23], v[100:103], v[40:55]
    s_nop 11
    v_max3_f32 v13, v40, v41, v42
    v_max3_f32 v14, v43, v44, v45
    v_max3_f32 v13, v13, v46, v47
    v_max3_f32 v14, v14, v48, v49
    v_max3_f32 v13, v13, v50, v51
    v_max3_f32 v14, v14, v52, v53
    v_max3_f32 v13, v13, v54, v55
    v_max_f32 v13, v13, v14
    v_cmp_lt_f32 vcc, s29, v13
    s_cbranch_vccz norescale_35
    v_mov_b32 v14, v13
    s_nop 1
    v_permlane32_swap_b32 v13, v14
    v_max_f32 v13, v13, v14
    v_max_f32 v13, 0, v13
    v_sub_f32 v14, 0, v13
    v_exp_f32 v14, v14
    v_sub_f32 v56, v56, v13
    v_sub_f32 v57, v57, v13
    v_sub_f32 v58, v58, v13
    v_sub_f32 v59, v59, v13
    v_sub_f32 v60, v60, v13
    v_sub_f32 v61, v61, v13
    v_sub_f32 v62, v62, v13
    v_sub_f32 v63, v63, v13
    v_sub_f32 v64, v64, v13
    v_sub_f32 v65, v65, v13
    v_sub_f32 v66, v66, v13
    v_sub_f32 v67, v67, v13
    v_sub_f32 v68, v68, v13
    v_sub_f32 v69, v69, v13
    v_sub_f32 v70, v70, v13
    v_sub_f32 v71, v71, v13
    v_mul_f32 v11, v11, v14
    v_mul_f32 v104, v104, v14
    v_mul_f32 v105, v105, v14
    v_mul_f32 v106, v106, v14
    v_mul_f32 v107, v107, v14
    v_mul_f32 v108, v108, v14
    v_mul_f32 v109, v109, v14
    v_mul_f32 v110, v110, v14
    v_mul_f32 v111, v111, v14
    v_mul_f32 v112, v112, v14
    v_mul_f32 v113, v113, v14
    v_mul_f32 v114, v114, v14
    v_mul_f32 v115, v115, v14
    v_mul_f32 v116, v116, v14
    v_mul_f32 v117, v117, v14
    v_mul_f32 v118, v118, v14
    v_mul_f32 v119, v119, v14
    v_mul_f32 v120, v120, v14
    v_mul_f32 v121, v121, v14
    v_mul_f32 v122, v122, v14
    v_mul_f32 v123, v123, v14
    v_mul_f32 v124, v124, v14
    v_mul_f32 v125, v125, v14
    v_mul_f32 v126, v126, v14
    v_mul_f32 v127, v127, v14
    v_mul_f32 v128, v128, v14
    v_mul_f32 v129, v129, v14
    v_mul_f32 v130, v130, v14
    v_mul_f32 v131, v131, v14
    v_mul_f32 v132, v132, v14
    v_mul_f32 v133, v133, v14
    v_mul_f32 v134, v134, v14
    v_mul_f32 v135, v135, v14
    v_mul_f32 v136, v136, v14
    v_mul_f32 v137, v137, v14
    v_mul_f32 v138, v138, v14
    v_mul_f32 v139, v139, v14
    v_mul_f32 v140, v140, v14
    v_mul_f32 v141, v141, v14
    v_mul_f32 v142, v142, v14
    v_mul_f32 v143, v143, v14
    v_mul_f32 v144, v144, v14
    v_mul_f32 v145, v145, v14
    v_mul_f32 v146, v146, v14
    v_mul_f32 v147, v147, v14
    v_mul_f32 v148, v148, v14
    v_mul_f32 v149, v149, v14
    v_mul_f32 v150, v150, v14
    v_mul_f32 v151, v151, v14
    v_mul_f32 v152, v152, v14
    v_mul_f32 v153, v153, v14
    v_mul_f32 v154, v154, v14
    v_mul_f32 v155, v155, v14
    v_mul_f32 v156, v156, v14
    v_mul_f32 v157, v157, v14
    v_mul_f32 v158, v158, v14
    v_mul_f32 v159, v159, v14
    v_mul_f32 v160, v160, v14
    v_mul_f32 v161, v161, v14
    v_mul_f32 v162, v162, v14
    v_mul_f32 v163, v163, v14
    v_mul_f32 v164, v164, v14
    v_mul_f32 v165, v165, v14
    v_mul_f32 v166, v166, v14
    v_mul_f32 v167, v167, v14
    v_sub_f32 v40, v40, v13
    v_sub_f32 v41, v41, v13
    v_sub_f32 v42, v42, v13
    v_sub_f32 v43, v43, v13
    v_sub_f32 v44, v44, v13
    v_sub_f32 v45, v45, v13
    v_sub_f32 v46, v46, v13
    v_sub_f32 v47, v47, v13
    v_sub_f32 v48, v48, v13
    v_sub_f32 v49, v49, v13
    v_sub_f32 v50, v50, v13
    v_sub_f32 v51, v51, v13
    v_sub_f32 v52, v52, v13
    v_sub_f32 v53, v53, v13
    v_sub_f32 v54, v54, v13
    v_sub_f32 v55, v55, v13
norescale_35:
    v_exp_f32 v40, v40
    v_exp_f32 v41, v41
    v_exp_f32 v42, v42
    v_exp_f32 v43, v43
    v_exp_f32 v44, v44
    v_exp_f32 v45, v45
    v_exp_f32 v46, v46
    v_exp_f32 v47, v47
    v_exp_f32 v48, v48
    v_exp_f32 v49, v49
    v_exp_f32 v50, v50
    v_exp_f32 v51, v51
    v_exp_f32 v52, v52
    v_exp_f32 v53, v53
    v_exp_f32 v54, v54
    v_exp_f32 v55, v55
    s_nop 0
    v_cvt_pk_bf16_f32 v40, v40, v41
    v_cvt_pk_bf16_f32 v41, v42, v43
    v_cvt_pk_bf16_f32 v42, v44, v45
    v_cvt_pk_bf16_f32 v43, v46, v47
    v_cvt_pk_bf16_f32 v44, v48, v49
    v_cvt_pk_bf16_f32 v45, v50, v51
    v_cvt_pk_bf16_f32 v46, v52, v53
    v_cvt_pk_bf16_f32 v47, v54, v55
    v_dot2c_f32_bf16 v11, s37, v40
    v_dot2c_f32_bf16 v11, s37, v41
    v_dot2c_f32_bf16 v11, s37, v42
    v_dot2c_f32_bf16 v11, s37, v43
    v_dot2c_f32_bf16 v11, s37, v44
    v_dot2c_f32_bf16 v11, s37, v45
    v_dot2c_f32_bf16 v11, s37, v46
    v_dot2c_f32_bf16 v11, s37, v47
    ds_read_b64_tr_b16 v[20:21], v6 offset:28672
    ds_read_b64_tr_b16 v[22:23], v6 offset:30720
    s_waitcnt lgkmcnt(10)
    v_mfma_f32_32x32x16_bf16 v[104:119], v[24:27], v[40:43], v[104:119]
    ds_read_b64_tr_b16 v[24:25], v7 offset:28672
    ds_read_b64_tr_b16 v[26:27], v7 offset:30720
    s_waitcnt lgkmcnt(10)
    v_mfma_f32_32x32x16_bf16 v[120:135], v[28:31], v[40:43], v[120:135]
    ds_read_b64_tr_b16 v[28:29], v8 offset:28672
    ds_read_b64_tr_b16 v[30:31], v8 offset:30720
    s_waitcnt lgkmcnt(10)
    v_mfma_f32_32x32x16_bf16 v[136:151], v[32:35], v[40:43], v[136:151]
    s_waitcnt lgkmcnt(8)
    v_mfma_f32_32x32x16_bf16 v[152:167], v[36:39], v[40:43], v[152:167]
    s_waitcnt lgkmcnt(6)
    v_mfma_f32_32x32x16_bf16 v[104:119], v[16:19], v[44:47], v[104:119]
    s_waitcnt lgkmcnt(4)
    v_mfma_f32_32x32x16_bf16 v[120:135], v[20:23], v[44:47], v[120:135]
    s_waitcnt lgkmcnt(2)
    v_mfma_f32_32x32x16_bf16 v[136:151], v[24:27], v[44:47], v[136:151]
    s_waitcnt lgkmcnt(0)
    v_mfma_f32_32x32x16_bf16 v[152:167], v[28:31], v[44:47], v[152:167]
    s_waitcnt vmcnt(12)
    s_barrier
    s_cmp_gt_u32 s4, 3
    s_cbranch_scc1 nodma_36
    s_add_u32 m0, s24, 16384
    s_add_u32 s25, s30, 2097152
    buffer_load_dwordx4 v0, s[72:75], s25 offen offset:0 lds
    s_add_u32 s25, s25, 31744
    buffer_load_dwordx4 v0, s[72:75], s25 offen offset:1024 lds
    s_add_u32 s25, s25, 31744
    buffer_load_dwordx4 v0, s[72:75], s25 offen offset:2048 lds
    s_add_u32 s25, s25, 31744
    buffer_load_dwordx4 v0, s[72:75], s25 offen offset:3072 lds
nodma_36:
    ds_read_b128 v[16:19], v9 offset:32768
    v_xor_b32 v15, 16, v9
    ds_read_b128 v[20:23], v15 offset:32768
    v_xor_b32 v15, 32, v9
    ds_read_b128 v[24:27], v15 offset:32768
    v_xor_b32 v15, 48, v9
    ds_read_b128 v[28:31], v15 offset:32768
    v_xor_b32 v15, 64, v9
    ds_read_b128 v[32:35], v15 offset:32768
    v_xor_b32 v15, 80, v9
    ds_read_b128 v[36:39], v15 offset:32768
    s_waitcnt lgkmcnt(5)
    v_mfma_f32_32x32x16_bf16 v[40:55], v[16:19], v[72:75], v[56:71]
    v_xor_b32 v15, 96, v9
    ds_read_b128 v[16:19], v15 offset:32768
    s_waitcnt lgkmcnt(5)
    v_mfma_f32_32x32x16_bf16 v[40:55], v[20:23], v[76:79], v[40:55]
    v_xor_b32 v15, 112, v9
    ds_read_b128 v[20:23], v15 offset:32768
    s_waitcnt lgkmcnt(5)
    v_mfma_f32_32x32x16_bf16 v[40:55], v[24:27], v[80:83], v[40:55]
    ds_read_b64_tr_b16 v[24:25], v5 offset:40960
    ds_read_b64_tr_b16 v[26:27], v5 offset:43008
    s_waitcnt lgkmcnt(6)
    v_mfma_f32_32x32x16_bf16 v[40:55], v[28:31], v[84:87], v[40:55]
    ds_read_b64_tr_b16 v[28:29], v6 offset:40960
    ds_read_b64_tr_b16 v[30:31], v6 offset:43008
    s_waitcnt lgkmcnt(7)
    v_mfma_f32_32x32x16_bf16 v[40:55], v[32:35], v[88:91], v[40:55]
    ds_read_b64_tr_b16 v[32:33], v7 offset:40960
    ds_read_b64_tr_b16 v[34:35], v7 offset:43008
    s_waitcnt lgkmcnt(8)
    v_mfma_f32_32x32x16_bf16 v[40:55], v[36:39], v[92:95], v[40:55]
    ds_read_b64_tr_b16 v[36:37], v8 offset:40960
    ds_read_b64_tr_b16 v[38:39], v8 offset:43008
    s_waitcnt lgkmcnt(9)
    v_mfma_f32_32x32x16_bf16 v[40:55], v[16:19], v[96:99], v[40:55]
    ds_read_b64_tr_b16 v[16:17], v5 offset:45056
    ds_read_b64_tr_b16 v[18:19], v5 offset:47104
    s_waitcnt lgkmcnt(10)
    v_mfma_f32_32x32x16_bf16 v[40:55], v[20:23], v[100:103], v[40:55]
    s_nop 11
    v_max3_f32 v13, v40, v41, v42
    v_max3_f32 v14, v43, v44, v45
    v_max3_f32 v13, v13, v46, v47
    v_max3_f32 v14, v14, v48, v49
    v_max3_f32 v13, v13, v50, v51
    v_max3_f32 v14, v14, v52, v53
    v_max3_f32 v13, v13, v54, v55
    v_max_f32 v13, v13, v14
    v_cmp_lt_f32 vcc, s29, v13
    s_cbranch_vccz norescale_37
    v_mov_b32 v14, v13
    s_nop 1
    v_permlane32_swap_b32 v13, v14
    v_max_f32 v13, v13, v14
    v_max_f32 v13, 0, v13
    v_sub_f32 v14, 0, v13
    v_exp_f32 v14, v14
    v_sub_f32 v56, v56, v13
    v_sub_f32 v57, v57, v13
    v_sub_f32 v58, v58, v13
    v_sub_f32 v59, v59, v13
    v_sub_f32 v60, v60, v13
    v_sub_f32 v61, v61, v13
    v_sub_f32 v62, v62, v13
    v_sub_f32 v63, v63, v13
    v_sub_f32 v64, v64, v13
    v_sub_f32 v65, v65, v13
    v_sub_f32 v66, v66, v13
    v_sub_f32 v67, v67, v13
    v_sub_f32 v68, v68, v13
    v_sub_f32 v69, v69, v13
    v_sub_f32 v70, v70, v13
    v_sub_f32 v71, v71, v13
    v_mul_f32 v11, v11, v14
    v_mul_f32 v104, v104, v14
    v_mul_f32 v105, v105, v14
    v_mul_f32 v106, v106, v14
    v_mul_f32 v107, v107, v14
    v_mul_f32 v108, v108, v14
    v_mul_f32 v109, v109, v14
    v_mul_f32 v110, v110, v14
    v_mul_f32 v111, v111, v14
    v_mul_f32 v112, v112, v14
    v_mul_f32 v113, v113, v14
    v_mul_f32 v114, v114, v14
    v_mul_f32 v115, v115, v14
    v_mul_f32 v116, v116, v14
    v_mul_f32 v117, v117, v14
    v_mul_f32 v118, v118, v14
    v_mul_f32 v119, v119, v14
    v_mul_f32 v120, v120, v14
    v_mul_f32 v121, v121, v14
    v_mul_f32 v122, v122, v14
    v_mul_f32 v123, v123, v14
    v_mul_f32 v124, v124, v14
    v_mul_f32 v125, v125, v14
    v_mul_f32 v126, v126, v14
    v_mul_f32 v127, v127, v14
    v_mul_f32 v128, v128, v14
    v_mul_f32 v129, v129, v14
    v_mul_f32 v130, v130, v14
    v_mul_f32 v131, v131, v14
    v_mul_f32 v132, v132, v14
    v_mul_f32 v133, v133, v14
    v_mul_f32 v134, v134, v14
    v_mul_f32 v135, v135, v14
    v_mul_f32 v136, v136, v14
    v_mul_f32 v137, v137, v14
    v_mul_f32 v138, v138, v14
    v_mul_f32 v139, v139, v14
    v_mul_f32 v140, v140, v14
    v_mul_f32 v141, v141, v14
    v_mul_f32 v142, v142, v14
    v_mul_f32 v143, v143, v14
    v_mul_f32 v144, v144, v14
    v_mul_f32 v145, v145, v14
    v_mul_f32 v146, v146, v14
    v_mul_f32 v147, v147, v14
    v_mul_f32 v148, v148, v14
    v_mul_f32 v149, v149, v14
    v_mul_f32 v150, v150, v14
    v_mul_f32 v151, v151, v14
    v_mul_f32 v152, v152, v14
    v_mul_f32 v153, v153, v14
    v_mul_f32 v154, v154, v14
    v_mul_f32 v155, v155, v14
    v_mul_f32 v156, v156, v14
    v_mul_f32 v157, v157, v14
    v_mul_f32 v158, v158, v14
    v_mul_f32 v159, v159, v14
    v_mul_f32 v160, v160, v14
    v_mul_f32 v161, v161, v14
    v_mul_f32 v162, v162, v14
    v_mul_f32 v163, v163, v14
    v_mul_f32 v164, v164, v14
    v_mul_f32 v165, v165, v14
    v_mul_f32 v166, v166, v14
    v_mul_f32 v167, v167, v14
    v_sub_f32 v40, v40, v13
    v_sub_f32 v41, v41, v13
    v_sub_f32 v42, v42, v13
    v_sub_f32 v43, v43, v13
    v_sub_f32 v44, v44, v13
    v_sub_f32 v45, v45, v13
    v_sub_f32 v46, v46, v13
    v_sub_f32 v47, v47, v13
    v_sub_f32 v48, v48, v13
    v_sub_f32 v49, v49, v13
    v_sub_f32 v50, v50, v13
    v_sub_f32 v51, v51, v13
    v_sub_f32 v52, v52, v13
    v_sub_f32 v53, v53, v13
    v_sub_f32 v54, v54, v13
    v_sub_f32 v55, v55, v13
norescale_37:
    v_exp_f32 v40, v40
    v_exp_f32 v41, v41
    v_exp_f32 v42, v42
    v_exp_f32 v43, v43
    v_exp_f32 v44, v44
    v_exp_f32 v45, v45
    v_exp_f32 v46, v46
    v_exp_f32 v47, v47
    v_exp_f32 v48, v48
    v_exp_f32 v49, v49
    v_exp_f32 v50, v50
    v_exp_f32 v51, v51
    v_exp_f32 v52, v52
    v_exp_f32 v53, v53
    v_exp_f32 v54, v54
    v_exp_f32 v55, v55
    s_nop 0
    v_cvt_pk_bf16_f32 v40, v40, v41
    v_cvt_pk_bf16_f32 v41, v42, v43
    v_cvt_pk_bf16_f32 v42, v44, v45
    v_cvt_pk_bf16_f32 v43, v46, v47
    v_cvt_pk_bf16_f32 v44, v48, v49
    v_cvt_pk_bf16_f32 v45, v50, v51
    v_cvt_pk_bf16_f32 v46, v52, v53
    v_cvt_pk_bf16_f32 v47, v54, v55
    v_dot2c_f32_bf16 v11, s37, v40
    v_dot2c_f32_bf16 v11, s37, v41
    v_dot2c_f32_bf16 v11, s37, v42
    v_dot2c_f32_bf16 v11, s37, v43
    v_dot2c_f32_bf16 v11, s37, v44
    v_dot2c_f32_bf16 v11, s37, v45
    v_dot2c_f32_bf16 v11, s37, v46
    v_dot2c_f32_bf16 v11, s37, v47
    ds_read_b64_tr_b16 v[20:21], v6 offset:45056
    ds_read_b64_tr_b16 v[22:23], v6 offset:47104
    s_waitcnt lgkmcnt(10)
    v_mfma_f32_32x32x16_bf16 v[104:119], v[24:27], v[40:43], v[104:119]
    ds_read_b64_tr_b16 v[24:25], v7 offset:45056
    ds_read_b64_tr_b16 v[26:27], v7 offset:47104
    s_waitcnt lgkmcnt(10)
    v_mfma_f32_32x32x16_bf16 v[120:135], v[28:31], v[40:43], v[120:135]
    ds_read_b64_tr_b16 v[28:29], v8 offset:45056
    ds_read_b64_tr_b16 v[30:31], v8 offset:47104
    s_waitcnt lgkmcnt(10)
    v_mfma_f32_32x32x16_bf16 v[136:151], v[32:35], v[40:43], v[136:151]
    s_waitcnt lgkmcnt(8)
    v_mfma_f32_32x32x16_bf16 v[152:167], v[36:39], v[40:43], v[152:167]
    s_waitcnt lgkmcnt(6)
    v_mfma_f32_32x32x16_bf16 v[104:119], v[16:19], v[44:47], v[104:119]
    s_waitcnt lgkmcnt(4)
    v_mfma_f32_32x32x16_bf16 v[120:135], v[20:23], v[44:47], v[120:135]
    s_waitcnt lgkmcnt(2)
    v_mfma_f32_32x32x16_bf16 v[136:151], v[24:27], v[44:47], v[136:151]
    s_waitcnt lgkmcnt(0)
    v_mfma_f32_32x32x16_bf16 v[152:167], v[28:31], v[44:47], v[152:167]
    s_waitcnt vmcnt(12)
    s_barrier
    s_cmp_gt_u32 s4, 3
    s_cbranch_scc1 nodma_38
    s_add_u32 m0, s24, 32768
    s_add_u32 s25, s30, 0
    buffer_load_dwordx4 v0, s[72:75], s25 offen offset:0 lds
    s_add_u32 s25, s25, 31744
    buffer_load_dwordx4 v0, s[72:75], s25 offen offset:1024 lds
    s_add_u32 s25, s25, 31744
    buffer_load_dwordx4 v0, s[72:75], s25 offen offset:2048 lds
    s_add_u32 s25, s25, 31744
    buffer_load_dwordx4 v0, s[72:75], s25 offen offset:3072 lds
nodma_38:
    ds_read_b128 v[16:19], v9 offset:49152
    v_xor_b32 v15, 16, v9
    ds_read_b128 v[20:23], v15 offset:49152
    v_xor_b32 v15, 32, v9
    ds_read_b128 v[24:27], v15 offset:49152
    v_xor_b32 v15, 48, v9
    ds_read_b128 v[28:31], v15 offset:49152
    v_xor_b32 v15, 64, v9
    ds_read_b128 v[32:35], v15 offset:49152
    v_xor_b32 v15, 80, v9
    ds_read_b128 v[36:39], v15 offset:49152
    s_waitcnt lgkmcnt(5)
    v_mfma_f32_32x32x16_bf16 v[40:55], v[16:19], v[72:75], v[56:71]
    v_xor_b32 v15, 96, v9
    ds_read_b128 v[16:19], v15 offset:49152
    s_waitcnt lgkmcnt(5)
    v_mfma_f32_32x32x16_bf16 v[40:55], v[20:23], v[76:79], v[40:55]
    v_xor_b32 v15, 112, v9
    ds_read_b128 v[20:23], v15 offset:49152
    s_waitcnt lgkmcnt(5)
    v_mfma_f32_32x32x16_bf16 v[40:55], v[24:27], v[80:83], v[40:55]
    ds_read_b64_tr_b16 v[24:25], v5 offset:57344
    ds_read_b64_tr_b16 v[26:27], v5 offset:59392
    s_waitcnt lgkmcnt(6)
    v_mfma_f32_32x32x16_bf16 v[40:55], v[28:31], v[84:87], v[40:55]
    ds_read_b64_tr_b16 v[28:29], v6 offset:57344
    ds_read_b64_tr_b16 v[30:31], v6 offset:59392
    s_waitcnt lgkmcnt(7)
    v_mfma_f32_32x32x16_bf16 v[40:55], v[32:35], v[88:91], v[40:55]
    ds_read_b64_tr_b16 v[32:33], v7 offset:57344
    ds_read_b64_tr_b16 v[34:35], v7 offset:59392
    s_waitcnt lgkmcnt(8)
    v_mfma_f32_32x32x16_bf16 v[40:55], v[36:39], v[92:95], v[40:55]
    ds_read_b64_tr_b16 v[36:37], v8 offset:57344
    ds_read_b64_tr_b16 v[38:39], v8 offset:59392
    s_waitcnt lgkmcnt(9)
    v_mfma_f32_32x32x16_bf16 v[40:55], v[16:19], v[96:99], v[40:55]
    ds_read_b64_tr_b16 v[16:17], v5 offset:61440
    ds_read_b64_tr_b16 v[18:19], v5 offset:63488
    s_waitcnt lgkmcnt(10)
    v_mfma_f32_32x32x16_bf16 v[40:55], v[20:23], v[100:103], v[40:55]
    s_nop 11
    v_max3_f32 v13, v40, v41, v42
    v_max3_f32 v14, v43, v44, v45
    v_max3_f32 v13, v13, v46, v47
    v_max3_f32 v14, v14, v48, v49
    v_max3_f32 v13, v13, v50, v51
    v_max3_f32 v14, v14, v52, v53
    v_max3_f32 v13, v13, v54, v55
    v_max_f32 v13, v13, v14
    v_cmp_lt_f32 vcc, s29, v13
    s_cbranch_vccz norescale_39
    v_mov_b32 v14, v13
    s_nop 1
    v_permlane32_swap_b32 v13, v14
    v_max_f32 v13, v13, v14
    v_max_f32 v13, 0, v13
    v_sub_f32 v14, 0, v13
    v_exp_f32 v14, v14
    v_sub_f32 v56, v56, v13
    v_sub_f32 v57, v57, v13
    v_sub_f32 v58, v58, v13
    v_sub_f32 v59, v59, v13
    v_sub_f32 v60, v60, v13
    v_sub_f32 v61, v61, v13
    v_sub_f32 v62, v62, v13
    v_sub_f32 v63, v63, v13
    v_sub_f32 v64, v64, v13
    v_sub_f32 v65, v65, v13
    v_sub_f32 v66, v66, v13
    v_sub_f32 v67, v67, v13
    v_sub_f32 v68, v68, v13
    v_sub_f32 v69, v69, v13
    v_sub_f32 v70, v70, v13
    v_sub_f32 v71, v71, v13
    v_mul_f32 v11, v11, v14
    v_mul_f32 v104, v104, v14
    v_mul_f32 v105, v105, v14
    v_mul_f32 v106, v106, v14
    v_mul_f32 v107, v107, v14
    v_mul_f32 v108, v108, v14
    v_mul_f32 v109, v109, v14
    v_mul_f32 v110, v110, v14
    v_mul_f32 v111, v111, v14
    v_mul_f32 v112, v112, v14
    v_mul_f32 v113, v113, v14
    v_mul_f32 v114, v114, v14
    v_mul_f32 v115, v115, v14
    v_mul_f32 v116, v116, v14
    v_mul_f32 v117, v117, v14
    v_mul_f32 v118, v118, v14
    v_mul_f32 v119, v119, v14
    v_mul_f32 v120, v120, v14
    v_mul_f32 v121, v121, v14
    v_mul_f32 v122, v122, v14
    v_mul_f32 v123, v123, v14
    v_mul_f32 v124, v124, v14
    v_mul_f32 v125, v125, v14
    v_mul_f32 v126, v126, v14
    v_mul_f32 v127, v127, v14
    v_mul_f32 v128, v128, v14
    v_mul_f32 v129, v129, v14
    v_mul_f32 v130, v130, v14
    v_mul_f32 v131, v131, v14
    v_mul_f32 v132, v132, v14
    v_mul_f32 v133, v133, v14
    v_mul_f32 v134, v134, v14
    v_mul_f32 v135, v135, v14
    v_mul_f32 v136, v136, v14
    v_mul_f32 v137, v137, v14
    v_mul_f32 v138, v138, v14
    v_mul_f32 v139, v139, v14
    v_mul_f32 v140, v140, v14
    v_mul_f32 v141, v141, v14
    v_mul_f32 v142, v142, v14
    v_mul_f32 v143, v143, v14
    v_mul_f32 v144, v144, v14
    v_mul_f32 v145, v145, v14
    v_mul_f32 v146, v146, v14
    v_mul_f32 v147, v147, v14
    v_mul_f32 v148, v148, v14
    v_mul_f32 v149, v149, v14
    v_mul_f32 v150, v150, v14
    v_mul_f32 v151, v151, v14
    v_mul_f32 v152, v152, v14
    v_mul_f32 v153, v153, v14
    v_mul_f32 v154, v154, v14
    v_mul_f32 v155, v155, v14
    v_mul_f32 v156, v156, v14
    v_mul_f32 v157, v157, v14
    v_mul_f32 v158, v158, v14
    v_mul_f32 v159, v159, v14
    v_mul_f32 v160, v160, v14
    v_mul_f32 v161, v161, v14
    v_mul_f32 v162, v162, v14
    v_mul_f32 v163, v163, v14
    v_mul_f32 v164, v164, v14
    v_mul_f32 v165, v165, v14
    v_mul_f32 v166, v166, v14
    v_mul_f32 v167, v167, v14
    v_sub_f32 v40, v40, v13
    v_sub_f32 v41, v41, v13
    v_sub_f32 v42, v42, v13
    v_sub_f32 v43, v43, v13
    v_sub_f32 v44, v44, v13
    v_sub_f32 v45, v45, v13
    v_sub_f32 v46, v46, v13
    v_sub_f32 v47, v47, v13
    v_sub_f32 v48, v48, v13
    v_sub_f32 v49, v49, v13
    v_sub_f32 v50, v50, v13
    v_sub_f32 v51, v51, v13
    v_sub_f32 v52, v52, v13
    v_sub_f32 v53, v53, v13
    v_sub_f32 v54, v54, v13
    v_sub_f32 v55, v55, v13
norescale_39:
    v_exp_f32 v40, v40
    v_exp_f32 v41, v41
    v_exp_f32 v42, v42
    v_exp_f32 v43, v43
    v_exp_f32 v44, v44
    v_exp_f32 v45, v45
    v_exp_f32 v46, v46
    v_exp_f32 v47, v47
    v_exp_f32 v48, v48
    v_exp_f32 v49, v49
    v_exp_f32 v50, v50
    v_exp_f32 v51, v51
    v_exp_f32 v52, v52
    v_exp_f32 v53, v53
    v_exp_f32 v54, v54
    v_exp_f32 v55, v55
    s_nop 0
    v_cvt_pk_bf16_f32 v40, v40, v41
    v_cvt_pk_bf16_f32 v41, v42, v43
    v_cvt_pk_bf16_f32 v42, v44, v45
    v_cvt_pk_bf16_f32 v43, v46, v47
    v_cvt_pk_bf16_f32 v44, v48, v49
    v_cvt_pk_bf16_f32 v45, v50, v51
    v_cvt_pk_bf16_f32 v46, v52, v53
    v_cvt_pk_bf16_f32 v47, v54, v55
    v_dot2c_f32_bf16 v11, s37, v40
    v_dot2c_f32_bf16 v11, s37, v41
    v_dot2c_f32_bf16 v11, s37, v42
    v_dot2c_f32_bf16 v11, s37, v43
    v_dot2c_f32_bf16 v11, s37, v44
    v_dot2c_f32_bf16 v11, s37, v45
    v_dot2c_f32_bf16 v11, s37, v46
    v_dot2c_f32_bf16 v11, s37, v47
    ds_read_b64_tr_b16 v[20:21], v6 offset:61440
    ds_read_b64_tr_b16 v[22:23], v6 offset:63488
    s_waitcnt lgkmcnt(10)
    v_mfma_f32_32x32x16_bf16 v[104:119], v[24:27], v[40:43], v[104:119]
    ds_read_b64_tr_b16 v[24:25], v7 offset:61440
    ds_read_b64_tr_b16 v[26:27], v7 offset:63488
    s_waitcnt lgkmcnt(10)
    v_mfma_f32_32x32x16_bf16 v[120:135], v[28:31], v[40:43], v[120:135]
    ds_read_b64_tr_b16 v[28:29], v8 offset:61440
    ds_read_b64_tr_b16 v[30:31], v8 offset:63488
    s_waitcnt lgkmcnt(10)
    v_mfma_f32_32x32x16_bf16 v[136:151], v[32:35], v[40:43], v[136:151]
    s_waitcnt lgkmcnt(8)
    v_mfma_f32_32x32x16_bf16 v[152:167], v[36:39], v[40:43], v[152:167]
    s_waitcnt lgkmcnt(6)
    v_mfma_f32_32x32x16_bf16 v[104:119], v[16:19], v[44:47], v[104:119]
    s_waitcnt lgkmcnt(4)
    v_mfma_f32_32x32x16_bf16 v[120:135], v[20:23], v[44:47], v[120:135]
    s_waitcnt lgkmcnt(2)
    v_mfma_f32_32x32x16_bf16 v[136:151], v[24:27], v[44:47], v[136:151]
    s_waitcnt lgkmcnt(0)
    v_mfma_f32_32x32x16_bf16 v[152:167], v[28:31], v[44:47], v[152:167]
    s_nop 15
    s_barrier
    s_cmp_gt_u32 s4, 3
    s_cbranch_scc1 nodma_40
    s_add_u32 m0, s24, 49152
    s_add_u32 s25, s30, 524288
    buffer_load_dwordx4 v0, s[72:75], s25 offen offset:0 lds
    s_add_u32 s25, s25, 31744
    buffer_load_dwordx4 v0, s[72:75], s25 offen offset:1024 lds
    s_add_u32 s25, s25, 31744
    buffer_load_dwordx4 v0, s[72:75], s25 offen offset:2048 lds
    s_add_u32 s25, s25, 31744
    buffer_load_dwordx4 v0, s[72:75], s25 offen offset:3072 lds
nodma_40:
    v_mov_b32 v14, v11
    v_and_b32 v16, 31, v10
    v_lshrrev_b32 v17, 5, v10
    v_permlane32_swap_b32 v11, v14
    v_add_f32 v11, v11, v14
    v_rcp_f32 v11, v11
    v_lshlrev_b32 v18, 12, v17
    v_lshl_add_u32 v18, v16, 4, v18
    s_lshl_b32 s7, s4, 18
    v_add_u32 v18, s7, v18
    v_mul_f32 v104, v104, v11
    v_mul_f32 v105, v105, v11
    v_mul_f32 v106, v106, v11
    v_mul_f32 v107, v107, v11
    v_mul_f32 v108, v108, v11
    v_mul_f32 v109, v109, v11
    v_mul_f32 v110, v110, v11
    v_mul_f32 v111, v111, v11
    v_mul_f32 v112, v112, v11
    v_mul_f32 v113, v113, v11
    v_mul_f32 v114, v114, v11
    v_mul_f32 v115, v115, v11
    v_mul_f32 v116, v116, v11
    v_mul_f32 v117, v117, v11
    v_mul_f32 v118, v118, v11
    v_mul_f32 v119, v119, v11
    v_mul_f32 v120, v120, v11
    v_mul_f32 v121, v121, v11
    v_mul_f32 v122, v122, v11
    v_mul_f32 v123, v123, v11
    v_mul_f32 v124, v124, v11
    v_mul_f32 v125, v125, v11
    v_mul_f32 v126, v126, v11
    v_mul_f32 v127, v127, v11
    v_mul_f32 v128, v128, v11
    v_mul_f32 v129, v129, v11
    v_mul_f32 v130, v130, v11
    v_mul_f32 v131, v131, v11
    v_mul_f32 v132, v132, v11
    v_mul_f32 v133, v133, v11
    v_mul_f32 v134, v134, v11
    v_mul_f32 v135, v135, v11
    v_mul_f32 v136, v136, v11
    v_mul_f32 v137, v137, v11
    v_mul_f32 v138, v138, v11
    v_mul_f32 v139, v139, v11
    v_mul_f32 v140, v140, v11
    v_mul_f32 v141, v141, v11
    v_mul_f32 v142, v142, v11
    v_mul_f32 v143, v143, v11
    v_mul_f32 v144, v144, v11
    v_mul_f32 v145, v145, v11
    v_mul_f32 v146, v146, v11
    v_mul_f32 v147, v147, v11
    v_mul_f32 v148, v148, v11
    v_mul_f32 v149, v149, v11
    v_mul_f32 v150, v150, v11
    v_mul_f32 v151, v151, v11
    v_mul_f32 v152, v152, v11
    v_mul_f32 v153, v153, v11
    v_mul_f32 v154, v154, v11
    v_mul_f32 v155, v155, v11
    v_mul_f32 v156, v156, v11
    v_mul_f32 v157, v157, v11
    v_mul_f32 v158, v158, v11
    v_mul_f32 v159, v159, v11
    v_mul_f32 v160, v160, v11
    v_mul_f32 v161, v161, v11
    v_mul_f32 v162, v162, v11
    v_mul_f32 v163, v163, v11
    v_mul_f32 v164, v164, v11
    v_mul_f32 v165, v165, v11
    v_mul_f32 v166, v166, v11
    v_mul_f32 v167, v167, v11
    v_cvt_pk_bf16_f32 v104, v104, v105
    v_cvt_pk_bf16_f32 v105, v106, v107
    v_cvt_pk_bf16_f32 v106, v108, v109
    v_cvt_pk_bf16_f32 v107, v110, v111
    v_cvt_pk_bf16_f32 v108, v112, v113
    v_cvt_pk_bf16_f32 v109, v114, v115
    v_cvt_pk_bf16_f32 v110, v116, v117
    v_cvt_pk_bf16_f32 v111, v118, v119
    v_cvt_pk_bf16_f32 v112, v120, v121
    v_cvt_pk_bf16_f32 v113, v122, v123
    v_cvt_pk_bf16_f32 v114, v124, v125
    v_cvt_pk_bf16_f32 v115, v126, v127
    v_cvt_pk_bf16_f32 v116, v128, v129
    v_cvt_pk_bf16_f32 v117, v130, v131
    v_cvt_pk_bf16_f32 v118, v132, v133
    v_cvt_pk_bf16_f32 v119, v134, v135
    v_cvt_pk_bf16_f32 v120, v136, v137
    v_cvt_pk_bf16_f32 v121, v138, v139
    v_cvt_pk_bf16_f32 v122, v140, v141
    v_cvt_pk_bf16_f32 v123, v142, v143
    v_cvt_pk_bf16_f32 v124, v144, v145
    v_cvt_pk_bf16_f32 v125, v146, v147
    v_cvt_pk_bf16_f32 v126, v148, v149
    v_cvt_pk_bf16_f32 v127, v150, v151
    v_cvt_pk_bf16_f32 v128, v152, v153
    v_cvt_pk_bf16_f32 v129, v154, v155
    v_cvt_pk_bf16_f32 v130, v156, v157
    v_cvt_pk_bf16_f32 v131, v158, v159
    v_cvt_pk_bf16_f32 v132, v160, v161
    v_cvt_pk_bf16_f32 v133, v162, v163
    v_cvt_pk_bf16_f32 v134, v164, v165
    v_cvt_pk_bf16_f32 v135, v166, v167
    buffer_store_dwordx4 v[104:107], v18, s[20:23], 0 offen offset:0
    buffer_store_dwordx4 v[108:111], v18, s[20:23], 0 offen offset:1024
    buffer_store_dwordx4 v[112:115], v18, s[20:23], 0 offen offset:2048
    buffer_store_dwordx4 v[116:119], v18, s[20:23], 0 offen offset:3072
    buffer_store_dwordx4 v[120:123], v18, s[20:23], 0 offen offset:512
    buffer_store_dwordx4 v[124:127], v18, s[20:23], 0 offen offset:1536
    buffer_store_dwordx4 v[128:131], v18, s[20:23], 0 offen offset:2560
    buffer_store_dwordx4 v[132:135], v18, s[20:23], 0 offen offset:3584
    s_mov_b32 s12, s72
    s_mov_b32 s13, s73
    s_mov_b32 s14, s74
    s_mov_b32 s15, s75
    v_add_u32 v5, v5, v12
    v_add_u32 v6, v6, v12
    v_add_u32 v7, v7, v12
    v_add_u32 v8, v8, v12
    s_mov_b32 s36, 1
    s_branch task_loop
tail_last:
    s_waitcnt vmcnt(8)
    s_barrier
    ds_read_b128 v[16:19], v9 offset:16384
    v_xor_b32 v15, 16, v9
    ds_read_b128 v[20:23], v15 offset:16384
    v_xor_b32 v15, 32, v9
    ds_read_b128 v[24:27], v15 offset:16384
    v_xor_b32 v15, 48, v9
    ds_read_b128 v[28:31], v15 offset:16384
    v_xor_b32 v15, 64, v9
    ds_read_b128 v[32:35], v15 offset:16384
    v_xor_b32 v15, 80, v9
    ds_read_b128 v[36:39], v15 offset:16384
    s_waitcnt lgkmcnt(5)
    v_mfma_f32_32x32x16_bf16 v[40:55], v[16:19], v[72:75], v[56:71]
    v_xor_b32 v15, 96, v9
    ds_read_b128 v[16:19], v15 offset:16384
    s_waitcnt lgkmcnt(5)
    v_mfma_f32_32x32x16_bf16 v[40:55], v[20:23], v[76:79], v[40:55]
    v_xor_b32 v15, 112, v9
    ds_read_b128 v[20:23], v15 offset:16384
    s_waitcnt lgkmcnt(5)
    v_mfma_f32_32x32x16_bf16 v[40:55], v[24:27], v[80:83], v[40:55]
    ds_read_b64_tr_b16 v[24:25], v5 offset:24576
    ds_read_b64_tr_b16 v[26:27], v5 offset:26624
    s_waitcnt lgkmcnt(6)
    v_mfma_f32_32x32x16_bf16 v[40:55], v[28:31], v[84:87], v[40:55]
    ds_read_b64_tr_b16 v[28:29], v6 offset:24576
    ds_read_b64_tr_b16 v[30:31], v6 offset:26624
    s_waitcnt lgkmcnt(7)
    v_mfma_f32_32x32x16_bf16 v[40:55], v[32:35], v[88:91], v[40:55]
    ds_read_b64_tr_b16 v[32:33], v7 offset:24576
    ds_read_b64_tr_b16 v[34:35], v7 offset:26624
    s_waitcnt lgkmcnt(8)
    v_mfma_f32_32x32x16_bf16 v[40:55], v[36:39], v[92:95], v[40:55]
    ds_read_b64_tr_b16 v[36:37], v8 offset:24576
    ds_read_b64_tr_b16 v[38:39], v8 offset:26624
    s_waitcnt lgkmcnt(9)
    v_mfma_f32_32x32x16_bf16 v[40:55], v[16:19], v[96:99], v[40:55]
    ds_read_b64_tr_b16 v[16:17], v5 offset:28672
    ds_read_b64_tr_b16 v[18:19], v5 offset:30720
    s_waitcnt lgkmcnt(10)
    v_mfma_f32_32x32x16_bf16 v[40:55], v[20:23], v[100:103], v[40:55]
    s_nop 11
    v_max3_f32 v13, v40, v41, v42
    v_max3_f32 v14, v43, v44, v45
    v_max3_f32 v13, v13, v46, v47
    v_max3_f32 v14, v14, v48, v49
    v_max3_f32 v13, v13, v50, v51
    v_max3_f32 v14, v14, v52, v53
    v_max3_f32 v13, v13, v54, v55
    v_max_f32 v13, v13, v14
    v_cmp_lt_f32 vcc, s29, v13
    s_cbranch_vccz norescale_41
    v_mov_b32 v14, v13
    s_nop 1
    v_permlane32_swap_b32 v13, v14
    v_max_f32 v13, v13, v14
    v_max_f32 v13, 0, v13
    v_sub_f32 v14, 0, v13
    v_exp_f32 v14, v14
    v_sub_f32 v56, v56, v13
    v_sub_f32 v57, v57, v13
    v_sub_f32 v58, v58, v13
    v_sub_f32 v59, v59, v13
    v_sub_f32 v60, v60, v13
    v_sub_f32 v61, v61, v13
    v_sub_f32 v62, v62, v13
    v_sub_f32 v63, v63, v13
    v_sub_f32 v64, v64, v13
    v_sub_f32 v65, v65, v13
    v_sub_f32 v66, v66, v13
    v_sub_f32 v67, v67, v13
    v_sub_f32 v68, v68, v13
    v_sub_f32 v69, v69, v13
    v_sub_f32 v70, v70, v13
    v_sub_f32 v71, v71, v13
    v_mul_f32 v11, v11, v14
    v_mul_f32 v104, v104, v14
    v_mul_f32 v105, v105, v14
    v_mul_f32 v106, v106, v14
    v_mul_f32 v107, v107, v14
    v_mul_f32 v108, v108, v14
    v_mul_f32 v109, v109, v14
    v_mul_f32 v110, v110, v14
    v_mul_f32 v111, v111, v14
    v_mul_f32 v112, v112, v14
    v_mul_f32 v113, v113, v14
    v_mul_f32 v114, v114, v14
    v_mul_f32 v115, v115, v14
    v_mul_f32 v116, v116, v14
    v_mul_f32 v117, v117, v14
    v_mul_f32 v118, v118, v14
    v_mul_f32 v119, v119, v14
    v_mul_f32 v120, v120, v14
    v_mul_f32 v121, v121, v14
    v_mul_f32 v122, v122, v14
    v_mul_f32 v123, v123, v14
    v_mul_f32 v124, v124, v14
    v_mul_f32 v125, v125, v14
    v_mul_f32 v126, v126, v14
    v_mul_f32 v127, v127, v14
    v_mul_f32 v128, v128, v14
    v_mul_f32 v129, v129, v14
    v_mul_f32 v130, v130, v14
    v_mul_f32 v131, v131, v14
    v_mul_f32 v132, v132, v14
    v_mul_f32 v133, v133, v14
    v_mul_f32 v134, v134, v14
    v_mul_f32 v135, v135, v14
    v_mul_f32 v136, v136, v14
    v_mul_f32 v137, v137, v14
    v_mul_f32 v138, v138, v14
    v_mul_f32 v139, v139, v14
    v_mul_f32 v140, v140, v14
    v_mul_f32 v141, v141, v14
    v_mul_f32 v142, v142, v14
    v_mul_f32 v143, v143, v14
    v_mul_f32 v144, v144, v14
    v_mul_f32 v145, v145, v14
    v_mul_f32 v146, v146, v14
    v_mul_f32 v147, v147, v14
    v_mul_f32 v148, v148, v14
    v_mul_f32 v149, v149, v14
    v_mul_f32 v150, v150, v14
    v_mul_f32 v151, v151, v14
    v_mul_f32 v152, v152, v14
    v_mul_f32 v153, v153, v14
    v_mul_f32 v154, v154, v14
    v_mul_f32 v155, v155, v14
    v_mul_f32 v156, v156, v14
    v_mul_f32 v157, v157, v14
    v_mul_f32 v158, v158, v14
    v_mul_f32 v159, v159, v14
    v_mul_f32 v160, v160, v14
    v_mul_f32 v161, v161, v14
    v_mul_f32 v162, v162, v14
    v_mul_f32 v163, v163, v14
    v_mul_f32 v164, v164, v14
    v_mul_f32 v165, v165, v14
    v_mul_f32 v166, v166, v14
    v_mul_f32 v167, v167, v14
    v_sub_f32 v40, v40, v13
    v_sub_f32 v41, v41, v13
    v_sub_f32 v42, v42, v13
    v_sub_f32 v43, v43, v13
    v_sub_f32 v44, v44, v13
    v_sub_f32 v45, v45, v13
    v_sub_f32 v46, v46, v13
    v_sub_f32 v47, v47, v13
    v_sub_f32 v48, v48, v13
    v_sub_f32 v49, v49, v13
    v_sub_f32 v50, v50, v13
    v_sub_f32 v51, v51, v13
    v_sub_f32 v52, v52, v13
    v_sub_f32 v53, v53, v13
    v_sub_f32 v54, v54, v13
    v_sub_f32 v55, v55, v13
norescale_41:
    v_exp_f32 v40, v40
    v_exp_f32 v41, v41
    v_exp_f32 v42, v42
    v_exp_f32 v43, v43
    v_exp_f32 v44, v44
    v_exp_f32 v45, v45
    v_exp_f32 v46, v46
    v_exp_f32 v47, v47
    v_exp_f32 v48, v48
    v_exp_f32 v49, v49
    v_exp_f32 v50, v50
    v_exp_f32 v51, v51
    v_exp_f32 v52, v52
    v_exp_f32 v53, v53
    v_exp_f32 v54, v54
    v_exp_f32 v55, v55
    s_nop 0
    v_cvt_pk_bf16_f32 v40, v40, v41
    v_cvt_pk_bf16_f32 v41, v42, v43
    v_cvt_pk_bf16_f32 v42, v44, v45
    v_cvt_pk_bf16_f32 v43, v46, v47
    v_cvt_pk_bf16_f32 v44, v48, v49
    v_cvt_pk_bf16_f32 v45, v50, v51
    v_cvt_pk_bf16_f32 v46, v52, v53
    v_cvt_pk_bf16_f32 v47, v54, v55
    v_dot2c_f32_bf16 v11, s37, v40
    v_dot2c_f32_bf16 v11, s37, v41
    v_dot2c_f32_bf16 v11, s37, v42
    v_dot2c_f32_bf16 v11, s37, v43
    v_dot2c_f32_bf16 v11, s37, v44
    v_dot2c_f32_bf16 v11, s37, v45
    v_dot2c_f32_bf16 v11, s37, v46
    v_dot2c_f32_bf16 v11, s37, v47
    ds_read_b64_tr_b16 v[20:21], v6 offset:28672
    ds_read_b64_tr_b16 v[22:23], v6 offset:30720
    s_waitcnt lgkmcnt(10)
    v_mfma_f32_32x32x16_bf16 v[104:119], v[24:27], v[40:43], v[104:119]
    ds_read_b64_tr_b16 v[24:25], v7 offset:28672
    ds_read_b64_tr_b16 v[26:27], v7 offset:30720
    s_waitcnt lgkmcnt(10)
    v_mfma_f32_32x32x16_bf16 v[120:135], v[28:31], v[40:43], v[120:135]
    ds_read_b64_tr_b16 v[28:29], v8 offset:28672
    ds_read_b64_tr_b16 v[30:31], v8 offset:30720
    s_waitcnt lgkmcnt(10)
    v_mfma_f32_32x32x16_bf16 v[136:151], v[32:35], v[40:43], v[136:151]
    s_waitcnt lgkmcnt(8)
    v_mfma_f32_32x32x16_bf16 v[152:167], v[36:39], v[40:43], v[152:167]
    s_waitcnt lgkmcnt(6)
    v_mfma_f32_32x32x16_bf16 v[104:119], v[16:19], v[44:47], v[104:119]
    s_waitcnt lgkmcnt(4)
    v_mfma_f32_32x32x16_bf16 v[120:135], v[20:23], v[44:47], v[120:135]
    s_waitcnt lgkmcnt(2)
    v_mfma_f32_32x32x16_bf16 v[136:151], v[24:27], v[44:47], v[136:151]
    s_waitcnt lgkmcnt(0)
    v_mfma_f32_32x32x16_bf16 v[152:167], v[28:31], v[44:47], v[152:167]
    s_waitcnt vmcnt(4)
    s_barrier
    ds_read_b128 v[16:19], v9 offset:32768
    v_xor_b32 v15, 16, v9
    ds_read_b128 v[20:23], v15 offset:32768
    v_xor_b32 v15, 32, v9
    ds_read_b128 v[24:27], v15 offset:32768
    v_xor_b32 v15, 48, v9
    ds_read_b128 v[28:31], v15 offset:32768
    v_xor_b32 v15, 64, v9
    ds_read_b128 v[32:35], v15 offset:32768
    v_xor_b32 v15, 80, v9
    ds_read_b128 v[36:39], v15 offset:32768
    s_waitcnt lgkmcnt(5)
    v_mfma_f32_32x32x16_bf16 v[40:55], v[16:19], v[72:75], v[56:71]
    v_xor_b32 v15, 96, v9
    ds_read_b128 v[16:19], v15 offset:32768
    s_waitcnt lgkmcnt(5)
    v_mfma_f32_32x32x16_bf16 v[40:55], v[20:23], v[76:79], v[40:55]
    v_xor_b32 v15, 112, v9
    ds_read_b128 v[20:23], v15 offset:32768
    s_waitcnt lgkmcnt(5)
    v_mfma_f32_32x32x16_bf16 v[40:55], v[24:27], v[80:83], v[40:55]
    ds_read_b64_tr_b16 v[24:25], v5 offset:40960
    ds_read_b64_tr_b16 v[26:27], v5 offset:43008
    s_waitcnt lgkmcnt(6)
    v_mfma_f32_32x32x16_bf16 v[40:55], v[28:31], v[84:87], v[40:55]
    ds_read_b64_tr_b16 v[28:29], v6 offset:40960
    ds_read_b64_tr_b16 v[30:31], v6 offset:43008
    s_waitcnt lgkmcnt(7)
    v_mfma_f32_32x32x16_bf16 v[40:55], v[32:35], v[88:91], v[40:55]
    ds_read_b64_tr_b16 v[32:33], v7 offset:40960
    ds_read_b64_tr_b16 v[34:35], v7 offset:43008
    s_waitcnt lgkmcnt(8)
    v_mfma_f32_32x32x16_bf16 v[40:55], v[36:39], v[92:95], v[40:55]
    ds_read_b64_tr_b16 v[36:37], v8 offset:40960
    ds_read_b64_tr_b16 v[38:39], v8 offset:43008
    s_waitcnt lgkmcnt(9)
    v_mfma_f32_32x32x16_bf16 v[40:55], v[16:19], v[96:99], v[40:55]
    ds_read_b64_tr_b16 v[16:17], v5 offset:45056
    ds_read_b64_tr_b16 v[18:19], v5 offset:47104
    s_waitcnt lgkmcnt(10)
    v_mfma_f32_32x32x16_bf16 v[40:55], v[20:23], v[100:103], v[40:55]
    s_nop 11
    v_max3_f32 v13, v40, v41, v42
    v_max3_f32 v14, v43, v44, v45
    v_max3_f32 v13, v13, v46, v47
    v_max3_f32 v14, v14, v48, v49
    v_max3_f32 v13, v13, v50, v51
    v_max3_f32 v14, v14, v52, v53
    v_max3_f32 v13, v13, v54, v55
    v_max_f32 v13, v13, v14
    v_cmp_lt_f32 vcc, s29, v13
    s_cbranch_vccz norescale_42
    v_mov_b32 v14, v13
    s_nop 1
    v_permlane32_swap_b32 v13, v14
    v_max_f32 v13, v13, v14
    v_max_f32 v13, 0, v13
    v_sub_f32 v14, 0, v13
    v_exp_f32 v14, v14
    v_sub_f32 v56, v56, v13
    v_sub_f32 v57, v57, v13
    v_sub_f32 v58, v58, v13
    v_sub_f32 v59, v59, v13
    v_sub_f32 v60, v60, v13
    v_sub_f32 v61, v61, v13
    v_sub_f32 v62, v62, v13
    v_sub_f32 v63, v63, v13
    v_sub_f32 v64, v64, v13
    v_sub_f32 v65, v65, v13
    v_sub_f32 v66, v66, v13
    v_sub_f32 v67, v67, v13
    v_sub_f32 v68, v68, v13
    v_sub_f32 v69, v69, v13
    v_sub_f32 v70, v70, v13
    v_sub_f32 v71, v71, v13
    v_mul_f32 v11, v11, v14
    v_mul_f32 v104, v104, v14
    v_mul_f32 v105, v105, v14
    v_mul_f32 v106, v106, v14
    v_mul_f32 v107, v107, v14
    v_mul_f32 v108, v108, v14
    v_mul_f32 v109, v109, v14
    v_mul_f32 v110, v110, v14
    v_mul_f32 v111, v111, v14
    v_mul_f32 v112, v112, v14
    v_mul_f32 v113, v113, v14
    v_mul_f32 v114, v114, v14
    v_mul_f32 v115, v115, v14
    v_mul_f32 v116, v116, v14
    v_mul_f32 v117, v117, v14
    v_mul_f32 v118, v118, v14
    v_mul_f32 v119, v119, v14
    v_mul_f32 v120, v120, v14
    v_mul_f32 v121, v121, v14
    v_mul_f32 v122, v122, v14
    v_mul_f32 v123, v123, v14
    v_mul_f32 v124, v124, v14
    v_mul_f32 v125, v125, v14
    v_mul_f32 v126, v126, v14
    v_mul_f32 v127, v127, v14
    v_mul_f32 v128, v128, v14
    v_mul_f32 v129, v129, v14
    v_mul_f32 v130, v130, v14
    v_mul_f32 v131, v131, v14
    v_mul_f32 v132, v132, v14
    v_mul_f32 v133, v133, v14
    v_mul_f32 v134, v134, v14
    v_mul_f32 v135, v135, v14
    v_mul_f32 v136, v136, v14
    v_mul_f32 v137, v137, v14
    v_mul_f32 v138, v138, v14
    v_mul_f32 v139, v139, v14
    v_mul_f32 v140, v140, v14
    v_mul_f32 v141, v141, v14
    v_mul_f32 v142, v142, v14
    v_mul_f32 v143, v143, v14
    v_mul_f32 v144, v144, v14
    v_mul_f32 v145, v145, v14
    v_mul_f32 v146, v146, v14
    v_mul_f32 v147, v147, v14
    v_mul_f32 v148, v148, v14
    v_mul_f32 v149, v149, v14
    v_mul_f32 v150, v150, v14
    v_mul_f32 v151, v151, v14
    v_mul_f32 v152, v152, v14
    v_mul_f32 v153, v153, v14
    v_mul_f32 v154, v154, v14
    v_mul_f32 v155, v155, v14
    v_mul_f32 v156, v156, v14
    v_mul_f32 v157, v157, v14
    v_mul_f32 v158, v158, v14
    v_mul_f32 v159, v159, v14
    v_mul_f32 v160, v160, v14
    v_mul_f32 v161, v161, v14
    v_mul_f32 v162, v162, v14
    v_mul_f32 v163, v163, v14
    v_mul_f32 v164, v164, v14
    v_mul_f32 v165, v165, v14
    v_mul_f32 v166, v166, v14
    v_mul_f32 v167, v167, v14
    v_sub_f32 v40, v40, v13
    v_sub_f32 v41, v41, v13
    v_sub_f32 v42, v42, v13
    v_sub_f32 v43, v43, v13
    v_sub_f32 v44, v44, v13
    v_sub_f32 v45, v45, v13
    v_sub_f32 v46, v46, v13
    v_sub_f32 v47, v47, v13
    v_sub_f32 v48, v48, v13
    v_sub_f32 v49, v49, v13
    v_sub_f32 v50, v50, v13
    v_sub_f32 v51, v51, v13
    v_sub_f32 v52, v52, v13
    v_sub_f32 v53, v53, v13
    v_sub_f32 v54, v54, v13
    v_sub_f32 v55, v55, v13
norescale_42:
    v_exp_f32 v40, v40
    v_exp_f32 v41, v41
    v_exp_f32 v42, v42
    v_exp_f32 v43, v43
    v_exp_f32 v44, v44
    v_exp_f32 v45, v45
    v_exp_f32 v46, v46
    v_exp_f32 v47, v47
    v_exp_f32 v48, v48
    v_exp_f32 v49, v49
    v_exp_f32 v50, v50
    v_exp_f32 v51, v51
    v_exp_f32 v52, v52
    v_exp_f32 v53, v53
    v_exp_f32 v54, v54
    v_exp_f32 v55, v55
    s_nop 0
    v_cvt_pk_bf16_f32 v40, v40, v41
    v_cvt_pk_bf16_f32 v41, v42, v43
    v_cvt_pk_bf16_f32 v42, v44, v45
    v_cvt_pk_bf16_f32 v43, v46, v47
    v_cvt_pk_bf16_f32 v44, v48, v49
    v_cvt_pk_bf16_f32 v45, v50, v51
    v_cvt_pk_bf16_f32 v46, v52, v53
    v_cvt_pk_bf16_f32 v47, v54, v55
    v_dot2c_f32_bf16 v11, s37, v40
    v_dot2c_f32_bf16 v11, s37, v41
    v_dot2c_f32_bf16 v11, s37, v42
    v_dot2c_f32_bf16 v11, s37, v43
    v_dot2c_f32_bf16 v11, s37, v44
    v_dot2c_f32_bf16 v11, s37, v45
    v_dot2c_f32_bf16 v11, s37, v46
    v_dot2c_f32_bf16 v11, s37, v47
    ds_read_b64_tr_b16 v[20:21], v6 offset:45056
    ds_read_b64_tr_b16 v[22:23], v6 offset:47104
    s_waitcnt lgkmcnt(10)
    v_mfma_f32_32x32x16_bf16 v[104:119], v[24:27], v[40:43], v[104:119]
    ds_read_b64_tr_b16 v[24:25], v7 offset:45056
    ds_read_b64_tr_b16 v[26:27], v7 offset:47104
    s_waitcnt lgkmcnt(10)
    v_mfma_f32_32x32x16_bf16 v[120:135], v[28:31], v[40:43], v[120:135]
    ds_read_b64_tr_b16 v[28:29], v8 offset:45056
    ds_read_b64_tr_b16 v[30:31], v8 offset:47104
    s_waitcnt lgkmcnt(10)
    v_mfma_f32_32x32x16_bf16 v[136:151], v[32:35], v[40:43], v[136:151]
    s_waitcnt lgkmcnt(8)
    v_mfma_f32_32x32x16_bf16 v[152:167], v[36:39], v[40:43], v[152:167]
    s_waitcnt lgkmcnt(6)
    v_mfma_f32_32x32x16_bf16 v[104:119], v[16:19], v[44:47], v[104:119]
    s_waitcnt lgkmcnt(4)
    v_mfma_f32_32x32x16_bf16 v[120:135], v[20:23], v[44:47], v[120:135]
    s_waitcnt lgkmcnt(2)
    v_mfma_f32_32x32x16_bf16 v[136:151], v[24:27], v[44:47], v[136:151]
    s_waitcnt lgkmcnt(0)
    v_mfma_f32_32x32x16_bf16 v[152:167], v[28:31], v[44:47], v[152:167]
    s_waitcnt vmcnt(0)
    s_barrier
    ds_read_b128 v[16:19], v9 offset:49152
    v_xor_b32 v15, 16, v9
    ds_read_b128 v[20:23], v15 offset:49152
    v_xor_b32 v15, 32, v9
    ds_read_b128 v[24:27], v15 offset:49152
    v_xor_b32 v15, 48, v9
    ds_read_b128 v[28:31], v15 offset:49152
    v_xor_b32 v15, 64, v9
    ds_read_b128 v[32:35], v15 offset:49152
    v_xor_b32 v15, 80, v9
    ds_read_b128 v[36:39], v15 offset:49152
    s_waitcnt lgkmcnt(5)
    v_mfma_f32_32x32x16_bf16 v[40:55], v[16:19], v[72:75], v[56:71]
    v_xor_b32 v15, 96, v9
    ds_read_b128 v[16:19], v15 offset:49152
    s_waitcnt lgkmcnt(5)
    v_mfma_f32_32x32x16_bf16 v[40:55], v[20:23], v[76:79], v[40:55]
    v_xor_b32 v15, 112, v9
    ds_read_b128 v[20:23], v15 offset:49152
    s_waitcnt lgkmcnt(5)
    v_mfma_f32_32x32x16_bf16 v[40:55], v[24:27], v[80:83], v[40:55]
    ds_read_b64_tr_b16 v[24:25], v5 offset:57344
    ds_read_b64_tr_b16 v[26:27], v5 offset:59392
    s_waitcnt lgkmcnt(6)
    v_mfma_f32_32x32x16_bf16 v[40:55], v[28:31], v[84:87], v[40:55]
    ds_read_b64_tr_b16 v[28:29], v6 offset:57344
    ds_read_b64_tr_b16 v[30:31], v6 offset:59392
    s_waitcnt lgkmcnt(7)
    v_mfma_f32_32x32x16_bf16 v[40:55], v[32:35], v[88:91], v[40:55]
    ds_read_b64_tr_b16 v[32:33], v7 offset:57344
    ds_read_b64_tr_b16 v[34:35], v7 offset:59392
    s_waitcnt lgkmcnt(8)
    v_mfma_f32_32x32x16_bf16 v[40:55], v[36:39], v[92:95], v[40:55]
    ds_read_b64_tr_b16 v[36:37], v8 offset:57344
    ds_read_b64_tr_b16 v[38:39], v8 offset:59392
    s_waitcnt lgkmcnt(9)
    v_mfma_f32_32x32x16_bf16 v[40:55], v[16:19], v[96:99], v[40:55]
    ds_read_b64_tr_b16 v[16:17], v5 offset:61440
    ds_read_b64_tr_b16 v[18:19], v5 offset:63488
    s_waitcnt lgkmcnt(10)
    v_mfma_f32_32x32x16_bf16 v[40:55], v[20:23], v[100:103], v[40:55]
    s_nop 11
    v_max3_f32 v13, v40, v41, v42
    v_max3_f32 v14, v43, v44, v45
    v_max3_f32 v13, v13, v46, v47
    v_max3_f32 v14, v14, v48, v49
    v_max3_f32 v13, v13, v50, v51
    v_max3_f32 v14, v14, v52, v53
    v_max3_f32 v13, v13, v54, v55
    v_max_f32 v13, v13, v14
    v_cmp_lt_f32 vcc, s29, v13
    s_cbranch_vccz norescale_43
    v_mov_b32 v14, v13
    s_nop 1
    v_permlane32_swap_b32 v13, v14
    v_max_f32 v13, v13, v14
    v_max_f32 v13, 0, v13
    v_sub_f32 v14, 0, v13
    v_exp_f32 v14, v14
    v_sub_f32 v56, v56, v13
    v_sub_f32 v57, v57, v13
    v_sub_f32 v58, v58, v13
    v_sub_f32 v59, v59, v13
    v_sub_f32 v60, v60, v13
    v_sub_f32 v61, v61, v13
    v_sub_f32 v62, v62, v13
    v_sub_f32 v63, v63, v13
    v_sub_f32 v64, v64, v13
    v_sub_f32 v65, v65, v13
    v_sub_f32 v66, v66, v13
    v_sub_f32 v67, v67, v13
    v_sub_f32 v68, v68, v13
    v_sub_f32 v69, v69, v13
    v_sub_f32 v70, v70, v13
    v_sub_f32 v71, v71, v13
    v_mul_f32 v11, v11, v14
    v_mul_f32 v104, v104, v14
    v_mul_f32 v105, v105, v14
    v_mul_f32 v106, v106, v14
    v_mul_f32 v107, v107, v14
    v_mul_f32 v108, v108, v14
    v_mul_f32 v109, v109, v14
    v_mul_f32 v110, v110, v14
    v_mul_f32 v111, v111, v14
    v_mul_f32 v112, v112, v14
    v_mul_f32 v113, v113, v14
    v_mul_f32 v114, v114, v14
    v_mul_f32 v115, v115, v14
    v_mul_f32 v116, v116, v14
    v_mul_f32 v117, v117, v14
    v_mul_f32 v118, v118, v14
    v_mul_f32 v119, v119, v14
    v_mul_f32 v120, v120, v14
    v_mul_f32 v121, v121, v14
    v_mul_f32 v122, v122, v14
    v_mul_f32 v123, v123, v14
    v_mul_f32 v124, v124, v14
    v_mul_f32 v125, v125, v14
    v_mul_f32 v126, v126, v14
    v_mul_f32 v127, v127, v14
    v_mul_f32 v128, v128, v14
    v_mul_f32 v129, v129, v14
    v_mul_f32 v130, v130, v14
    v_mul_f32 v131, v131, v14
    v_mul_f32 v132, v132, v14
    v_mul_f32 v133, v133, v14
    v_mul_f32 v134, v134, v14
    v_mul_f32 v135, v135, v14
    v_mul_f32 v136, v136, v14
    v_mul_f32 v137, v137, v14
    v_mul_f32 v138, v138, v14
    v_mul_f32 v139, v139, v14
    v_mul_f32 v140, v140, v14
    v_mul_f32 v141, v141, v14
    v_mul_f32 v142, v142, v14
    v_mul_f32 v143, v143, v14
    v_mul_f32 v144, v144, v14
    v_mul_f32 v145, v145, v14
    v_mul_f32 v146, v146, v14
    v_mul_f32 v147, v147, v14
    v_mul_f32 v148, v148, v14
    v_mul_f32 v149, v149, v14
    v_mul_f32 v150, v150, v14
    v_mul_f32 v151, v151, v14
    v_mul_f32 v152, v152, v14
    v_mul_f32 v153, v153, v14
    v_mul_f32 v154, v154, v14
    v_mul_f32 v155, v155, v14
    v_mul_f32 v156, v156, v14
    v_mul_f32 v157, v157, v14
    v_mul_f32 v158, v158, v14
    v_mul_f32 v159, v159, v14
    v_mul_f32 v160, v160, v14
    v_mul_f32 v161, v161, v14
    v_mul_f32 v162, v162, v14
    v_mul_f32 v163, v163, v14
    v_mul_f32 v164, v164, v14
    v_mul_f32 v165, v165, v14
    v_mul_f32 v166, v166, v14
    v_mul_f32 v167, v167, v14
    v_sub_f32 v40, v40, v13
    v_sub_f32 v41, v41, v13
    v_sub_f32 v42, v42, v13
    v_sub_f32 v43, v43, v13
    v_sub_f32 v44, v44, v13
    v_sub_f32 v45, v45, v13
    v_sub_f32 v46, v46, v13
    v_sub_f32 v47, v47, v13
    v_sub_f32 v48, v48, v13
    v_sub_f32 v49, v49, v13
    v_sub_f32 v50, v50, v13
    v_sub_f32 v51, v51, v13
    v_sub_f32 v52, v52, v13
    v_sub_f32 v53, v53, v13
    v_sub_f32 v54, v54, v13
    v_sub_f32 v55, v55, v13
norescale_43:
    v_exp_f32 v40, v40
    v_exp_f32 v41, v41
    v_exp_f32 v42, v42
    v_exp_f32 v43, v43
    v_exp_f32 v44, v44
    v_exp_f32 v45, v45
    v_exp_f32 v46, v46
    v_exp_f32 v47, v47
    v_exp_f32 v48, v48
    v_exp_f32 v49, v49
    v_exp_f32 v50, v50
    v_exp_f32 v51, v51
    v_exp_f32 v52, v52
    v_exp_f32 v53, v53
    v_exp_f32 v54, v54
    v_exp_f32 v55, v55
    s_nop 0
    v_cvt_pk_bf16_f32 v40, v40, v41
    v_cvt_pk_bf16_f32 v41, v42, v43
    v_cvt_pk_bf16_f32 v42, v44, v45
    v_cvt_pk_bf16_f32 v43, v46, v47
    v_cvt_pk_bf16_f32 v44, v48, v49
    v_cvt_pk_bf16_f32 v45, v50, v51
    v_cvt_pk_bf16_f32 v46, v52, v53
    v_cvt_pk_bf16_f32 v47, v54, v55
    v_dot2c_f32_bf16 v11, s37, v40
    v_dot2c_f32_bf16 v11, s37, v41
    v_dot2c_f32_bf16 v11, s37, v42
    v_dot2c_f32_bf16 v11, s37, v43
    v_dot2c_f32_bf16 v11, s37, v44
    v_dot2c_f32_bf16 v11, s37, v45
    v_dot2c_f32_bf16 v11, s37, v46
    v_dot2c_f32_bf16 v11, s37, v47
    ds_read_b64_tr_b16 v[20:21], v6 offset:61440
    ds_read_b64_tr_b16 v[22:23], v6 offset:63488
    s_waitcnt lgkmcnt(10)
    v_mfma_f32_32x32x16_bf16 v[104:119], v[24:27], v[40:43], v[104:119]
    ds_read_b64_tr_b16 v[24:25], v7 offset:61440
    ds_read_b64_tr_b16 v[26:27], v7 offset:63488
    s_waitcnt lgkmcnt(10)
    v_mfma_f32_32x32x16_bf16 v[120:135], v[28:31], v[40:43], v[120:135]
    ds_read_b64_tr_b16 v[28:29], v8 offset:61440
    ds_read_b64_tr_b16 v[30:31], v8 offset:63488
    s_waitcnt lgkmcnt(10)
    v_mfma_f32_32x32x16_bf16 v[136:151], v[32:35], v[40:43], v[136:151]
    s_waitcnt lgkmcnt(8)
    v_mfma_f32_32x32x16_bf16 v[152:167], v[36:39], v[40:43], v[152:167]
    s_waitcnt lgkmcnt(6)
    v_mfma_f32_32x32x16_bf16 v[104:119], v[16:19], v[44:47], v[104:119]
    s_waitcnt lgkmcnt(4)
    v_mfma_f32_32x32x16_bf16 v[120:135], v[20:23], v[44:47], v[120:135]
    s_waitcnt lgkmcnt(2)
    v_mfma_f32_32x32x16_bf16 v[136:151], v[24:27], v[44:47], v[136:151]
    s_waitcnt lgkmcnt(0)
    v_mfma_f32_32x32x16_bf16 v[152:167], v[28:31], v[44:47], v[152:167]
    s_nop 15
    v_mov_b32 v14, v11
    v_and_b32 v16, 31, v10
    v_lshrrev_b32 v17, 5, v10
    v_permlane32_swap_b32 v11, v14
    v_add_f32 v11, v11, v14
    v_rcp_f32 v11, v11
    v_lshlrev_b32 v18, 12, v17
    v_lshl_add_u32 v18, v16, 4, v18
    s_lshl_b32 s7, s4, 18
    v_add_u32 v18, s7, v18
    v_mul_f32 v104, v104, v11
    v_mul_f32 v105, v105, v11
    v_mul_f32 v106, v106, v11
    v_mul_f32 v107, v107, v11
    v_mul_f32 v108, v108, v11
    v_mul_f32 v109, v109, v11
    v_mul_f32 v110, v110, v11
    v_mul_f32 v111, v111, v11
    v_mul_f32 v112, v112, v11
    v_mul_f32 v113, v113, v11
    v_mul_f32 v114, v114, v11
    v_mul_f32 v115, v115, v11
    v_mul_f32 v116, v116, v11
    v_mul_f32 v117, v117, v11
    v_mul_f32 v118, v118, v11
    v_mul_f32 v119, v119, v11
    v_mul_f32 v120, v120, v11
    v_mul_f32 v121, v121, v11
    v_mul_f32 v122, v122, v11
    v_mul_f32 v123, v123, v11
    v_mul_f32 v124, v124, v11
    v_mul_f32 v125, v125, v11
    v_mul_f32 v126, v126, v11
    v_mul_f32 v127, v127, v11
    v_mul_f32 v128, v128, v11
    v_mul_f32 v129, v129, v11
    v_mul_f32 v130, v130, v11
    v_mul_f32 v131, v131, v11
    v_mul_f32 v132, v132, v11
    v_mul_f32 v133, v133, v11
    v_mul_f32 v134, v134, v11
    v_mul_f32 v135, v135, v11
    v_mul_f32 v136, v136, v11
    v_mul_f32 v137, v137, v11
    v_mul_f32 v138, v138, v11
    v_mul_f32 v139, v139, v11
    v_mul_f32 v140, v140, v11
    v_mul_f32 v141, v141, v11
    v_mul_f32 v142, v142, v11
    v_mul_f32 v143, v143, v11
    v_mul_f32 v144, v144, v11
    v_mul_f32 v145, v145, v11
    v_mul_f32 v146, v146, v11
    v_mul_f32 v147, v147, v11
    v_mul_f32 v148, v148, v11
    v_mul_f32 v149, v149, v11
    v_mul_f32 v150, v150, v11
    v_mul_f32 v151, v151, v11
    v_mul_f32 v152, v152, v11
    v_mul_f32 v153, v153, v11
    v_mul_f32 v154, v154, v11
    v_mul_f32 v155, v155, v11
    v_mul_f32 v156, v156, v11
    v_mul_f32 v157, v157, v11
    v_mul_f32 v158, v158, v11
    v_mul_f32 v159, v159, v11
    v_mul_f32 v160, v160, v11
    v_mul_f32 v161, v161, v11
    v_mul_f32 v162, v162, v11
    v_mul_f32 v163, v163, v11
    v_mul_f32 v164, v164, v11
    v_mul_f32 v165, v165, v11
    v_mul_f32 v166, v166, v11
    v_mul_f32 v167, v167, v11
    v_cvt_pk_bf16_f32 v104, v104, v105
    v_cvt_pk_bf16_f32 v105, v106, v107
    v_cvt_pk_bf16_f32 v106, v108, v109
    v_cvt_pk_bf16_f32 v107, v110, v111
    v_cvt_pk_bf16_f32 v108, v112, v113
    v_cvt_pk_bf16_f32 v109, v114, v115
    v_cvt_pk_bf16_f32 v110, v116, v117
    v_cvt_pk_bf16_f32 v111, v118, v119
    v_cvt_pk_bf16_f32 v112, v120, v121
    v_cvt_pk_bf16_f32 v113, v122, v123
    v_cvt_pk_bf16_f32 v114, v124, v125
    v_cvt_pk_bf16_f32 v115, v126, v127
    v_cvt_pk_bf16_f32 v116, v128, v129
    v_cvt_pk_bf16_f32 v117, v130, v131
    v_cvt_pk_bf16_f32 v118, v132, v133
    v_cvt_pk_bf16_f32 v119, v134, v135
    v_cvt_pk_bf16_f32 v120, v136, v137
    v_cvt_pk_bf16_f32 v121, v138, v139
    v_cvt_pk_bf16_f32 v122, v140, v141
    v_cvt_pk_bf16_f32 v123, v142, v143
    v_cvt_pk_bf16_f32 v124, v144, v145
    v_cvt_pk_bf16_f32 v125, v146, v147
    v_cvt_pk_bf16_f32 v126, v148, v149
    v_cvt_pk_bf16_f32 v127, v150, v151
    v_cvt_pk_bf16_f32 v128, v152, v153
    v_cvt_pk_bf16_f32 v129, v154, v155
    v_cvt_pk_bf16_f32 v130, v156, v157
    v_cvt_pk_bf16_f32 v131, v158, v159
    v_cvt_pk_bf16_f32 v132, v160, v161
    v_cvt_pk_bf16_f32 v133, v162, v163
    v_cvt_pk_bf16_f32 v134, v164, v165
    v_cvt_pk_bf16_f32 v135, v166, v167
    buffer_store_dwordx4 v[104:107], v18, s[20:23], 0 offen offset:0
    buffer_store_dwordx4 v[108:111], v18, s[20:23], 0 offen offset:1024
    buffer_store_dwordx4 v[112:115], v18, s[20:23], 0 offen offset:2048
    buffer_store_dwordx4 v[116:119], v18, s[20:23], 0 offen offset:3072
    buffer_store_dwordx4 v[120:123], v18, s[20:23], 0 offen offset:512
    buffer_store_dwordx4 v[124:127], v18, s[20:23], 0 offen offset:1536
    buffer_store_dwordx4 v[128:131], v18, s[20:23], 0 offen offset:2560
    buffer_store_dwordx4 v[132:135], v18, s[20:23], 0 offen offset:3584
attn_end:
    s_endpgm
.globl oproj_kernel
.p2align 8
.type oproj_kernel,@function
oproj_kernel:
    s_cmp_ge_u32 s2, 256
    s_cbranch_scc1 oproj_end
    s_load_dwordx2 s[40:41], s[0:1], 32
    s_load_dwordx2 s[42:43], s[0:1], 72
    s_load_dwordx2 s[44:45], s[0:1], 80
    s_load_dwordx2 s[46:47], s[0:1], 96
    v_lshrrev_b32 v1, 6, v0
    v_and_b32 v0, 63, v0
    s_bfe_u32 s3, s2, 0x10002
    v_readfirstlane_b32 s4, v1
    s_and_b32 s5, s2, 3
    s_lshl_b32 s5, s5, 2
    s_bfe_u32 s6, s2, 0x20003
    s_add_u32 s5, s5, s6
    s_lshr_b32 s6, s2, 5
    s_cmp_ge_u32 s4, 5
    s_cselect_b32 s23, 1, 0
    s_mul_i32 s7, s23, 5
    s_sub_u32 s4, s4, s7
    s_waitcnt lgkmcnt(0)
    s_cmp_eq_u32 s3, 0
    s_cselect_b64 s[40:41], s[40:41], s[42:43]
    s_mul_i32 s7, s3, 20971520
    s_mul_i32 s34, s5, 1310720
    s_add_u32 s7, s7, s34
    s_lshl_b32 s36, s23, 17
    s_add_u32 s7, s7, s36
    s_add_u32 s8, s46, s7
    s_addc_u32 s9, s47, 0
    s_sub_u32 s10, 1310720, s36
    s_mov_b32 s11, 0x00020000
    s_lshl_b32 s7, s6, 7
    s_lshl_b32 s36, s23, 21
    s_add_u32 s36, s36, s7
    s_add_u32 s12, s40, s36
    s_addc_u32 s13, s41, 0
    s_sub_u32 s14, 4194304, s36
    s_mov_b32 s15, 0x00020000
    s_mul_i32 s34, s5, 327680
    s_lshl_b32 s35, s3, 10
    s_add_u32 s35, s35, s7
    s_add_u32 s34, s34, s35
    s_add_u32 s16, s44, s34
    s_addc_u32 s17, s45, 0
    s_sub_u32 s18, 327680, s35
    s_mov_b32 s19, 0x00020000
    s_mul_i32 s37, s23, 49152
    s_lshl_b32 s20, s4, 11
    s_add_u32 s20, s20, s37
    s_lshl_b32 s22, s4, 14
    v_lshrrev_b32 v16, 3, v0
    v_and_b32 v17, 7, v0
    v_bfe_u32 v18, v16, 1, 1
    v_lshlrev_b32 v18, 1, v18
    v_xor_b32 v18, v17, v18
    v_lshlrev_b32 v18, 4, v18
    v_lshl_add_u32 v1, v16, 10, v18
    v_and_b32 v16, 31, v0
    v_lshrrev_b32 v17, 5, v0
    v_lshlrev_b32 v18, 6, v17
    v_lshlrev_b32 v2, 4, v0
    v_lshl_add_u32 v5, v16, 11, v18
    s_lshl_b32 s7, s4, 18
    v_add_u32 v2, s7, v2
    s_lshl_b32 s7, s4, 16
    v_add_u32 v5, s7, v5
    s_lshl_b32 s7, s4, 13
    v_lshlrev_b32 v6, 4, v0
    v_add_u32 v6, s7, v6
    v_bfe_u32 v18, v0, 2, 2
    v_and_b32 v19, 3, v0
    v_bfe_u32 v20, v0, 4, 1
    v_and_b32 v21, 1, v19
    v_lshlrev_b32 v21, 6, v21
    v_lshl_add_u32 v21, v20, 4, v21
    v_lshrrev_b32 v22, 1, v19
    v_lshl_add_u32 v21, v22, 3, v21
    v_lshl_add_u32 v21, v18, 7, v21
    v_lshl_add_u32 v21, v17, 12, v21
    v_add_u32 v21, s37, v21
    v_lshrrev_b32 v18, 1, v18
    v_xor_b32 v22, 0, v18
    v_lshl_add_u32 v3, v22, 5, v21
    v_xor_b32 v22, 1, v18
    v_lshl_add_u32 v4, v22, 5, v21
    v_mov_b32 v136, 0
    v_mov_b32 v137, 0
    v_mov_b32 v138, 0
    v_mov_b32 v139, 0
    v_mov_b32 v140, 0
    v_mov_b32 v141, 0
    v_mov_b32 v142, 0
    v_mov_b32 v143, 0
    v_mov_b32 v144, 0
    v_mov_b32 v145, 0
    v_mov_b32 v146, 0
    v_mov_b32 v147, 0
    v_mov_b32 v148, 0
    v_mov_b32 v149, 0
    v_mov_b32 v150, 0
    v_mov_b32 v151, 0
    v_mov_b32 v152, 0
    v_mov_b32 v153, 0
    v_mov_b32 v154, 0
    v_mov_b32 v155, 0
    v_mov_b32 v156, 0
    v_mov_b32 v157, 0
    v_mov_b32 v158, 0
    v_mov_b32 v159, 0
    v_mov_b32 v160, 0
    v_mov_b32 v161, 0
    v_mov_b32 v162, 0
    v_mov_b32 v163, 0
    v_mov_b32 v164, 0
    v_mov_b32 v165, 0
    v_mov_b32 v166, 0
    v_mov_b32 v167, 0
    s_cmp_gt_u32 s4, 3
    s_cbranch_scc1 nodma_10001
    s_add_u32 m0, s20, 0
    s_add_u32 s21, s22, 0
    buffer_load_dwordx4 v1, s[12:15], s21 offen lds
    s_add_u32 s21, s21, 7168
    buffer_load_dwordx4 v1, s[12:15], s21 offen offset:1024 lds
nodma_10001:
    s_mov_b32 s21, 0
    buffer_load_dwordx4 v[40:43], v2, s[8:11], s21 offen offset:0
    buffer_load_dwordx4 v[44:47], v2, s[8:11], s21 offen offset:1024
    buffer_load_dwordx4 v[48:51], v2, s[8:11], s21 offen offset:2048
    buffer_load_dwordx4 v[52:55], v2, s[8:11], s21 offen offset:3072
    s_cmp_gt_u32 s4, 3
    s_cbranch_scc1 nodma_10002
    s_add_u32 m0, s20, 8192
    s_add_u32 s21, s22, 65536
    buffer_load_dwordx4 v1, s[12:15], s21 offen lds
    s_add_u32 s21, s21, 7168
    buffer_load_dwordx4 v1, s[12:15], s21 offen offset:1024 lds
nodma_10002:
    s_mov_b32 s21, 4096
    buffer_load_dwordx4 v[56:59], v2, s[8:11], s21 offen offset:0
    buffer_load_dwordx4 v[60:63], v2, s[8:11], s21 offen offset:1024
    buffer_load_dwordx4 v[64:67], v2, s[8:11], s21 offen offset:2048
    buffer_load_dwordx4 v[68:71], v2, s[8:11], s21 offen offset:3072
    s_cmp_gt_u32 s4, 3
    s_cbranch_scc1 nodma_10003
    s_add_u32 m0, s20, 16384
    s_add_u32 s21, s22, 131072
    buffer_load_dwordx4 v1, s[12:15], s21 offen lds
    s_add_u32 s21, s21, 7168
    buffer_load_dwordx4 v1, s[12:15], s21 offen offset:1024 lds
nodma_10003:
    s_mov_b32 s21, 8192
    buffer_load_dwordx4 v[72:75], v2, s[8:11], s21 offen offset:0
    buffer_load_dwordx4 v[76:79], v2, s[8:11], s21 offen offset:1024
    buffer_load_dwordx4 v[80:83], v2, s[8:11], s21 offen offset:2048
    buffer_load_dwordx4 v[84:87], v2, s[8:11], s21 offen offset:3072
    s_cmp_gt_u32 s4, 3
    s_cbranch_scc1 nodma_10004
    s_add_u32 m0, s20, 24576
    s_add_u32 s21, s22, 196608
    buffer_load_dwordx4 v1, s[12:15], s21 offen lds
    s_add_u32 s21, s21, 7168
    buffer_load_dwordx4 v1, s[12:15], s21 offen offset:1024 lds
nodma_10004:
    s_mov_b32 s21, 12288
    buffer_load_dwordx4 v[88:91], v2, s[8:11], s21 offen offset:0
    buffer_load_dwordx4 v[92:95], v2, s[8:11], s21 offen offset:1024
    buffer_load_dwordx4 v[96:99], v2, s[8:11], s21 offen offset:2048
    buffer_load_dwordx4 v[100:103], v2, s[8:11], s21 offen offset:3072
    s_cmp_gt_u32 s4, 3
    s_cbranch_scc1 nodma_10005
    s_add_u32 m0, s20, 32768
    s_add_u32 s21, s22, 262144
    buffer_load_dwordx4 v1, s[12:15], s21 offen lds
    s_add_u32 s21, s21, 7168
    buffer_load_dwordx4 v1, s[12:15], s21 offen offset:1024 lds
nodma_10005:
    s_mov_b32 s21, 16384
    buffer_load_dwordx4 v[104:107], v2, s[8:11], s21 offen offset:0
    buffer_load_dwordx4 v[108:111], v2, s[8:11], s21 offen offset:1024
    buffer_load_dwordx4 v[112:115], v2, s[8:11], s21 offen offset:2048
    buffer_load_dwordx4 v[116:119], v2, s[8:11], s21 offen offset:3072
    s_cmp_gt_u32 s4, 3
    s_cbranch_scc1 w4_10006
    s_waitcnt vmcnt(24)
    s_branch wj_10007
w4_10006:
    s_waitcnt vmcnt(16)
wj_10007:
    s_barrier
    s_cmp_gt_u32 s4, 3
    s_cbranch_scc1 nodma_10008
    s_add_u32 m0, s20, 40960
    s_add_u32 s21, s22, 327680
    buffer_load_dwordx4 v1, s[12:15], s21 offen lds
    s_add_u32 s21, s21, 7168
    buffer_load_dwordx4 v1, s[12:15], s21 offen offset:1024 lds
nodma_10008:
    s_mov_b32 s21, 20480
    buffer_load_dwordx4 v[120:123], v2, s[8:11], s21 offen offset:0
    buffer_load_dwordx4 v[124:127], v2, s[8:11], s21 offen offset:1024
    buffer_load_dwordx4 v[128:131], v2, s[8:11], s21 offen offset:2048
    buffer_load_dwordx4 v[132:135], v2, s[8:11], s21 offen offset:3072
    ds_read_b64_tr_b16 v[8:9], v3 offset:0
    ds_read_b64_tr_b16 v[10:11], v3 offset:512
    ds_read_b64_tr_b16 v[12:13], v4 offset:0
    ds_read_b64_tr_b16 v[14:15], v4 offset:512
    ds_read_b64_tr_b16 v[16:17], v3 offset:1024
    ds_read_b64_tr_b16 v[18:19], v3 offset:1536
    ds_read_b64_tr_b16 v[20:21], v4 offset:1024
    ds_read_b64_tr_b16 v[22:23], v4 offset:1536
    ds_read_b64_tr_b16 v[24:25], v3 offset:2048
    ds_read_b64_tr_b16 v[26:27], v3 offset:2560
    ds_read_b64_tr_b16 v[28:29], v4 offset:2048
    ds_read_b64_tr_b16 v[30:31], v4 offset:2560
    ds_read_b64_tr_b16 v[32:33], v3 offset:3072
    ds_read_b64_tr_b16 v[34:35], v3 offset:3584
    ds_read_b64_tr_b16 v[36:37], v4 offset:3072
    ds_read_b64_tr_b16 v[38:39], v4 offset:3584
    s_waitcnt lgkmcnt(12)
    v_mfma_f32_32x32x16_bf16 v[136:151], v[8:11], v[40:43], v[136:151]
    v_mfma_f32_32x32x16_bf16 v[152:167], v[12:15], v[40:43], v[152:167]
    s_waitcnt lgkmcnt(8)
    v_mfma_f32_32x32x16_bf16 v[136:151], v[16:19], v[44:47], v[136:151]
    v_mfma_f32_32x32x16_bf16 v[152:167], v[20:23], v[44:47], v[152:167]
    s_waitcnt lgkmcnt(4)
    v_mfma_f32_32x32x16_bf16 v[136:151], v[24:27], v[48:51], v[136:151]
    v_mfma_f32_32x32x16_bf16 v[152:167], v[28:31], v[48:51], v[152:167]
    s_waitcnt lgkmcnt(0)
    v_mfma_f32_32x32x16_bf16 v[136:151], v[32:35], v[52:55], v[136:151]
    v_mfma_f32_32x32x16_bf16 v[152:167], v[36:39], v[52:55], v[152:167]
    s_cmp_gt_u32 s4, 3
    s_cbranch_scc1 w4_10009
    s_waitcnt vmcnt(24)
    s_branch wj_10010
w4_10009:
    s_waitcnt vmcnt(16)
wj_10010:
    s_barrier
    s_cmp_gt_u32 s4, 3
    s_cbranch_scc1 nodma_10011
    s_add_u32 m0, s20, 0
    s_add_u32 s21, s22, 393216
    buffer_load_dwordx4 v1, s[12:15], s21 offen lds
    s_add_u32 s21, s21, 7168
    buffer_load_dwordx4 v1, s[12:15], s21 offen offset:1024 lds
nodma_10011:
    s_mov_b32 s21, 24576
    buffer_load_dwordx4 v[40:43], v2, s[8:11], s21 offen offset:0
    buffer_load_dwordx4 v[44:47], v2, s[8:11], s21 offen offset:1024
    buffer_load_dwordx4 v[48:51], v2, s[8:11], s21 offen offset:2048
    buffer_load_dwordx4 v[52:55], v2, s[8:11], s21 offen offset:3072
    ds_read_b64_tr_b16 v[8:9], v3 offset:8192
    ds_read_b64_tr_b16 v[10:11], v3 offset:8704
    ds_read_b64_tr_b16 v[12:13], v4 offset:8192
    ds_read_b64_tr_b16 v[14:15], v4 offset:8704
    ds_read_b64_tr_b16 v[16:17], v3 offset:9216
    ds_read_b64_tr_b16 v[18:19], v3 offset:9728
    ds_read_b64_tr_b16 v[20:21], v4 offset:9216
    ds_read_b64_tr_b16 v[22:23], v4 offset:9728
    ds_read_b64_tr_b16 v[24:25], v3 offset:10240
    ds_read_b64_tr_b16 v[26:27], v3 offset:10752
    ds_read_b64_tr_b16 v[28:29], v4 offset:10240
    ds_read_b64_tr_b16 v[30:31], v4 offset:10752
    ds_read_b64_tr_b16 v[32:33], v3 offset:11264
    ds_read_b64_tr_b16 v[34:35], v3 offset:11776
    ds_read_b64_tr_b16 v[36:37], v4 offset:11264
    ds_read_b64_tr_b16 v[38:39], v4 offset:11776
    s_waitcnt lgkmcnt(12)
    v_mfma_f32_32x32x16_bf16 v[136:151], v[8:11], v[56:59], v[136:151]
    v_mfma_f32_32x32x16_bf16 v[152:167], v[12:15], v[56:59], v[152:167]
    s_waitcnt lgkmcnt(8)
    v_mfma_f32_32x32x16_bf16 v[136:151], v[16:19], v[60:63], v[136:151]
    v_mfma_f32_32x32x16_bf16 v[152:167], v[20:23], v[60:63], v[152:167]
    s_waitcnt lgkmcnt(4)
    v_mfma_f32_32x32x16_bf16 v[136:151], v[24:27], v[64:67], v[136:151]
    v_mfma_f32_32x32x16_bf16 v[152:167], v[28:31], v[64:67], v[152:167]
    s_waitcnt lgkmcnt(0)
    v_mfma_f32_32x32x16_bf16 v[136:151], v[32:35], v[68:71], v[136:151]
    v_mfma_f32_32x32x16_bf16 v[152:167], v[36:39], v[68:71], v[152:167]
    s_cmp_gt_u32 s4, 3
    s_cbranch_scc1 w4_10012
    s_waitcnt vmcnt(24)
    s_branch wj_10013
w4_10012:
    s_waitcnt vmcnt(16)
wj_10013:
    s_barrier
    s_cmp_gt_u32 s4, 3
    s_cbranch_scc1 nodma_10014
    s_add_u32 m0, s20, 8192
    s_add_u32 s21, s22, 458752
    buffer_load_dwordx4 v1, s[12:15], s21 offen lds
    s_add_u32 s21, s21, 7168
    buffer_load_dwordx4 v1, s[12:15], s21 offen offset:1024 lds
nodma_10014:
    s_mov_b32 s21, 28672
    buffer_load_dwordx4 v[56:59], v2, s[8:11], s21 offen offset:0
    buffer_load_dwordx4 v[60:63], v2, s[8:11], s21 offen offset:1024
    buffer_load_dwordx4 v[64:67], v2, s[8:11], s21 offen offset:2048
    buffer_load_dwordx4 v[68:71], v2, s[8:11], s21 offen offset:3072
    ds_read_b64_tr_b16 v[8:9], v3 offset:16384
    ds_read_b64_tr_b16 v[10:11], v3 offset:16896
    ds_read_b64_tr_b16 v[12:13], v4 offset:16384
    ds_read_b64_tr_b16 v[14:15], v4 offset:16896
    ds_read_b64_tr_b16 v[16:17], v3 offset:17408
    ds_read_b64_tr_b16 v[18:19], v3 offset:17920
    ds_read_b64_tr_b16 v[20:21], v4 offset:17408
    ds_read_b64_tr_b16 v[22:23], v4 offset:17920
    ds_read_b64_tr_b16 v[24:25], v3 offset:18432
    ds_read_b64_tr_b16 v[26:27], v3 offset:18944
    ds_read_b64_tr_b16 v[28:29], v4 offset:18432
    ds_read_b64_tr_b16 v[30:31], v4 offset:18944
    ds_read_b64_tr_b16 v[32:33], v3 offset:19456
    ds_read_b64_tr_b16 v[34:35], v3 offset:19968
    ds_read_b64_tr_b16 v[36:37], v4 offset:19456
    ds_read_b64_tr_b16 v[38:39], v4 offset:19968
    s_waitcnt lgkmcnt(12)
    v_mfma_f32_32x32x16_bf16 v[136:151], v[8:11], v[72:75], v[136:151]
    v_mfma_f32_32x32x16_bf16 v[152:167], v[12:15], v[72:75], v[152:167]
    s_waitcnt lgkmcnt(8)
    v_mfma_f32_32x32x16_bf16 v[136:151], v[16:19], v[76:79], v[136:151]
    v_mfma_f32_32x32x16_bf16 v[152:167], v[20:23], v[76:79], v[152:167]
    s_waitcnt lgkmcnt(4)
    v_mfma_f32_32x32x16_bf16 v[136:151], v[24:27], v[80:83], v[136:151]
    v_mfma_f32_32x32x16_bf16 v[152:167], v[28:31], v[80:83], v[152:167]
    s_waitcnt lgkmcnt(0)
    v_mfma_f32_32x32x16_bf16 v[136:151], v[32:35], v[84:87], v[136:151]
    v_mfma_f32_32x32x16_bf16 v[152:167], v[36:39], v[84:87], v[152:167]
    s_cmp_gt_u32 s4, 3
    s_cbranch_scc1 w4_10015
    s_waitcnt vmcnt(24)
    s_branch wj_10016
w4_10015:
    s_waitcnt vmcnt(16)
wj_10016:
    s_barrier
    s_cmp_gt_u32 s4, 3
    s_cbranch_scc1 nodma_10017
    s_add_u32 m0, s20, 16384
    s_add_u32 s21, s22, 524288
    buffer_load_dwordx4 v1, s[12:15], s21 offen lds
    s_add_u32 s21, s21, 7168
    buffer_load_dwordx4 v1, s[12:15], s21 offen offset:1024 lds
nodma_10017:
    s_mov_b32 s21, 32768
    buffer_load_dwordx4 v[72:75], v2, s[8:11], s21 offen offset:0
    buffer_load_dwordx4 v[76:79], v2, s[8:11], s21 offen offset:1024
    buffer_load_dwordx4 v[80:83], v2, s[8:11], s21 offen offset:2048
    buffer_load_dwordx4 v[84:87], v2, s[8:11], s21 offen offset:3072
    ds_read_b64_tr_b16 v[8:9], v3 offset:24576
    ds_read_b64_tr_b16 v[10:11], v3 offset:25088
    ds_read_b64_tr_b16 v[12:13], v4 offset:24576
    ds_read_b64_tr_b16 v[14:15], v4 offset:25088
    ds_read_b64_tr_b16 v[16:17], v3 offset:25600
    ds_read_b64_tr_b16 v[18:19], v3 offset:26112
    ds_read_b64_tr_b16 v[20:21], v4 offset:25600
    ds_read_b64_tr_b16 v[22:23], v4 offset:26112
    ds_read_b64_tr_b16 v[24:25], v3 offset:26624
    ds_read_b64_tr_b16 v[26:27], v3 offset:27136
    ds_read_b64_tr_b16 v[28:29], v4 offset:26624
    ds_read_b64_tr_b16 v[30:31], v4 offset:27136
    ds_read_b64_tr_b16 v[32:33], v3 offset:27648
    ds_read_b64_tr_b16 v[34:35], v3 offset:28160
    ds_read_b64_tr_b16 v[36:37], v4 offset:27648
    ds_read_b64_tr_b16 v[38:39], v4 offset:28160
    s_waitcnt lgkmcnt(12)
    v_mfma_f32_32x32x16_bf16 v[136:151], v[8:11], v[88:91], v[136:151]
    v_mfma_f32_32x32x16_bf16 v[152:167], v[12:15], v[88:91], v[152:167]
    s_waitcnt lgkmcnt(8)
    v_mfma_f32_32x32x16_bf16 v[136:151], v[16:19], v[92:95], v[136:151]
    v_mfma_f32_32x32x16_bf16 v[152:167], v[20:23], v[92:95], v[152:167]
    s_waitcnt lgkmcnt(4)
    v_mfma_f32_32x32x16_bf16 v[136:151], v[24:27], v[96:99], v[136:151]
    v_mfma_f32_32x32x16_bf16 v[152:167], v[28:31], v[96:99], v[152:167]
    s_waitcnt lgkmcnt(0)
    v_mfma_f32_32x32x16_bf16 v[136:151], v[32:35], v[100:103], v[136:151]
    v_mfma_f32_32x32x16_bf16 v[152:167], v[36:39], v[100:103], v[152:167]
    s_cmp_gt_u32 s4, 3
    s_cbranch_scc1 w4_10018
    s_waitcnt vmcnt(24)
    s_branch wj_10019
w4_10018:
    s_waitcnt vmcnt(16)
wj_10019:
    s_barrier
    s_cmp_gt_u32 s4, 3
    s_cbranch_scc1 nodma_10020
    s_add_u32 m0, s20, 24576
    s_add_u32 s21, s22, 589824
    buffer_load_dwordx4 v1, s[12:15], s21 offen lds
    s_add_u32 s21, s21, 7168
    buffer_load_dwordx4 v1, s[12:15], s21 offen offset:1024 lds
nodma_10020:
    s_mov_b32 s21, 36864
    buffer_load_dwordx4 v[88:91], v2, s[8:11], s21 offen offset:0
    buffer_load_dwordx4 v[92:95], v2, s[8:11], s21 offen offset:1024
    buffer_load_dwordx4 v[96:99], v2, s[8:11], s21 offen offset:2048
    buffer_load_dwordx4 v[100:103], v2, s[8:11], s21 offen offset:3072
    ds_read_b64_tr_b16 v[8:9], v3 offset:32768
    ds_read_b64_tr_b16 v[10:11], v3 offset:33280
    ds_read_b64_tr_b16 v[12:13], v4 offset:32768
    ds_read_b64_tr_b16 v[14:15], v4 offset:33280
    ds_read_b64_tr_b16 v[16:17], v3 offset:33792
    ds_read_b64_tr_b16 v[18:19], v3 offset:34304
    ds_read_b64_tr_b16 v[20:21], v4 offset:33792
    ds_read_b64_tr_b16 v[22:23], v4 offset:34304
    ds_read_b64_tr_b16 v[24:25], v3 offset:34816
    ds_read_b64_tr_b16 v[26:27], v3 offset:35328
    ds_read_b64_tr_b16 v[28:29], v4 offset:34816
    ds_read_b64_tr_b16 v[30:31], v4 offset:35328
    ds_read_b64_tr_b16 v[32:33], v3 offset:35840
    ds_read_b64_tr_b16 v[34:35], v3 offset:36352
    ds_read_b64_tr_b16 v[36:37], v4 offset:35840
    ds_read_b64_tr_b16 v[38:39], v4 offset:36352
    s_waitcnt lgkmcnt(12)
    v_mfma_f32_32x32x16_bf16 v[136:151], v[8:11], v[104:107], v[136:151]
    v_mfma_f32_32x32x16_bf16 v[152:167], v[12:15], v[104:107], v[152:167]
    s_waitcnt lgkmcnt(8)
    v_mfma_f32_32x32x16_bf16 v[136:151], v[16:19], v[108:111], v[136:151]
    v_mfma_f32_32x32x16_bf16 v[152:167], v[20:23], v[108:111], v[152:167]
    s_waitcnt lgkmcnt(4)
    v_mfma_f32_32x32x16_bf16 v[136:151], v[24:27], v[112:115], v[136:151]
    v_mfma_f32_32x32x16_bf16 v[152:167], v[28:31], v[112:115], v[152:167]
    s_waitcnt lgkmcnt(0)
    v_mfma_f32_32x32x16_bf16 v[136:151], v[32:35], v[116:119], v[136:151]
    v_mfma_f32_32x32x16_bf16 v[152:167], v[36:39], v[116:119], v[152:167]
    s_cmp_gt_u32 s4, 3
    s_cbranch_scc1 w4_10021
    s_waitcnt vmcnt(24)
    s_branch wj_10022
w4_10021:
    s_waitcnt vmcnt(16)
wj_10022:
    s_barrier
    s_cmp_gt_u32 s4, 3
    s_cbranch_scc1 nodma_10023
    s_add_u32 m0, s20, 32768
    s_add_u32 s21, s22, 655360
    buffer_load_dwordx4 v1, s[12:15], s21 offen lds
    s_add_u32 s21, s21, 7168
    buffer_load_dwordx4 v1, s[12:15], s21 offen offset:1024 lds
nodma_10023:
    s_mov_b32 s21, 40960
    buffer_load_dwordx4 v[104:107], v2, s[8:11], s21 offen offset:0
    buffer_load_dwordx4 v[108:111], v2, s[8:11], s21 offen offset:1024
    buffer_load_dwordx4 v[112:115], v2, s[8:11], s21 offen offset:2048
    buffer_load_dwordx4 v[116:119], v2, s[8:11], s21 offen offset:3072
    ds_read_b64_tr_b16 v[8:9], v3 offset:40960
    ds_read_b64_tr_b16 v[10:11], v3 offset:41472
    ds_read_b64_tr_b16 v[12:13], v4 offset:40960
    ds_read_b64_tr_b16 v[14:15], v4 offset:41472
    ds_read_b64_tr_b16 v[16:17], v3 offset:41984
    ds_read_b64_tr_b16 v[18:19], v3 offset:42496
    ds_read_b64_tr_b16 v[20:21], v4 offset:41984
    ds_read_b64_tr_b16 v[22:23], v4 offset:42496
    ds_read_b64_tr_b16 v[24:25], v3 offset:43008
    ds_read_b64_tr_b16 v[26:27], v3 offset:43520
    ds_read_b64_tr_b16 v[28:29], v4 offset:43008
    ds_read_b64_tr_b16 v[30:31], v4 offset:43520
    ds_read_b64_tr_b16 v[32:33], v3 offset:44032
    ds_read_b64_tr_b16 v[34:35], v3 offset:44544
    ds_read_b64_tr_b16 v[36:37], v4 offset:44032
    ds_read_b64_tr_b16 v[38:39], v4 offset:44544
    s_waitcnt lgkmcnt(12)
    v_mfma_f32_32x32x16_bf16 v[136:151], v[8:11], v[120:123], v[136:151]
    v_mfma_f32_32x32x16_bf16 v[152:167], v[12:15], v[120:123], v[152:167]
    s_waitcnt lgkmcnt(8)
    v_mfma_f32_32x32x16_bf16 v[136:151], v[16:19], v[124:127], v[136:151]
    v_mfma_f32_32x32x16_bf16 v[152:167], v[20:23], v[124:127], v[152:167]
    s_waitcnt lgkmcnt(4)
    v_mfma_f32_32x32x16_bf16 v[136:151], v[24:27], v[128:131], v[136:151]
    v_mfma_f32_32x32x16_bf16 v[152:167], v[28:31], v[128:131], v[152:167]
    s_waitcnt lgkmcnt(0)
    v_mfma_f32_32x32x16_bf16 v[136:151], v[32:35], v[132:135], v[136:151]
    v_mfma_f32_32x32x16_bf16 v[152:167], v[36:39], v[132:135], v[152:167]
    s_cmp_gt_u32 s4, 3
    s_cbranch_scc1 w4_10024
    s_waitcnt vmcnt(24)
    s_branch wj_10025
w4_10024:
    s_waitcnt vmcnt(16)
wj_10025:
    s_barrier
    s_cmp_gt_u32 s4, 3
    s_cbranch_scc1 nodma_10026
    s_add_u32 m0, s20, 40960
    s_add_u32 s21, s22, 720896
    buffer_load_dwordx4 v1, s[12:15], s21 offen lds
    s_add_u32 s21, s21, 7168
    buffer_load_dwordx4 v1, s[12:15], s21 offen offset:1024 lds
nodma_10026:
    s_mov_b32 s21, 45056
    buffer_load_dwordx4 v[120:123], v2, s[8:11], s21 offen offset:0
    buffer_load_dwordx4 v[124:127], v2, s[8:11], s21 offen offset:1024
    buffer_load_dwordx4 v[128:131], v2, s[8:11], s21 offen offset:2048
    buffer_load_dwordx4 v[132:135], v2, s[8:11], s21 offen offset:3072
    ds_read_b64_tr_b16 v[8:9], v3 offset:0
    ds_read_b64_tr_b16 v[10:11], v3 offset:512
    ds_read_b64_tr_b16 v[12:13], v4 offset:0
    ds_read_b64_tr_b16 v[14:15], v4 offset:512
    ds_read_b64_tr_b16 v[16:17], v3 offset:1024
    ds_read_b64_tr_b16 v[18:19], v3 offset:1536
    ds_read_b64_tr_b16 v[20:21], v4 offset:1024
    ds_read_b64_tr_b16 v[22:23], v4 offset:1536
    ds_read_b64_tr_b16 v[24:25], v3 offset:2048
    ds_read_b64_tr_b16 v[26:27], v3 offset:2560
    ds_read_b64_tr_b16 v[28:29], v4 offset:2048
    ds_read_b64_tr_b16 v[30:31], v4 offset:2560
    ds_read_b64_tr_b16 v[32:33], v3 offset:3072
    ds_read_b64_tr_b16 v[34:35], v3 offset:3584
    ds_read_b64_tr_b16 v[36:37], v4 offset:3072
    ds_read_b64_tr_b16 v[38:39], v4 offset:3584
    s_waitcnt lgkmcnt(12)
    v_mfma_f32_32x32x16_bf16 v[136:151], v[8:11], v[40:43], v[136:151]
    v_mfma_f32_32x32x16_bf16 v[152:167], v[12:15], v[40:43], v[152:167]
    s_waitcnt lgkmcnt(8)
    v_mfma_f32_32x32x16_bf16 v[136:151], v[16:19], v[44:47], v[136:151]
    v_mfma_f32_32x32x16_bf16 v[152:167], v[20:23], v[44:47], v[152:167]
    s_waitcnt lgkmcnt(4)
    v_mfma_f32_32x32x16_bf16 v[136:151], v[24:27], v[48:51], v[136:151]
    v_mfma_f32_32x32x16_bf16 v[152:167], v[28:31], v[48:51], v[152:167]
    s_waitcnt lgkmcnt(0)
    v_mfma_f32_32x32x16_bf16 v[136:151], v[32:35], v[52:55], v[136:151]
    v_mfma_f32_32x32x16_bf16 v[152:167], v[36:39], v[52:55], v[152:167]
    s_cmp_gt_u32 s4, 3
    s_cbranch_scc1 w4_10027
    s_waitcnt vmcnt(24)
    s_branch wj_10028
w4_10027:
    s_waitcnt vmcnt(16)
wj_10028:
    s_barrier
    s_cmp_gt_u32 s4, 3
    s_cbranch_scc1 nodma_10029
    s_add_u32 m0, s20, 0
    s_add_u32 s21, s22, 786432
    buffer_load_dwordx4 v1, s[12:15], s21 offen lds
    s_add_u32 s21, s21, 7168
    buffer_load_dwordx4 v1, s[12:15], s21 offen offset:1024 lds
nodma_10029:
    s_mov_b32 s21, 49152
    buffer_load_dwordx4 v[40:43], v2, s[8:11], s21 offen offset:0
    buffer_load_dwordx4 v[44:47], v2, s[8:11], s21 offen offset:1024
    buffer_load_dwordx4 v[48:51], v2, s[8:11], s21 offen offset:2048
    buffer_load_dwordx4 v[52:55], v2, s[8:11], s21 offen offset:3072
    ds_read_b64_tr_b16 v[8:9], v3 offset:8192
    ds_read_b64_tr_b16 v[10:11], v3 offset:8704
    ds_read_b64_tr_b16 v[12:13], v4 offset:8192
    ds_read_b64_tr_b16 v[14:15], v4 offset:8704
    ds_read_b64_tr_b16 v[16:17], v3 offset:9216
    ds_read_b64_tr_b16 v[18:19], v3 offset:9728
    ds_read_b64_tr_b16 v[20:21], v4 offset:9216
    ds_read_b64_tr_b16 v[22:23], v4 offset:9728
    ds_read_b64_tr_b16 v[24:25], v3 offset:10240
    ds_read_b64_tr_b16 v[26:27], v3 offset:10752
    ds_read_b64_tr_b16 v[28:29], v4 offset:10240
    ds_read_b64_tr_b16 v[30:31], v4 offset:10752
    ds_read_b64_tr_b16 v[32:33], v3 offset:11264
    ds_read_b64_tr_b16 v[34:35], v3 offset:11776
    ds_read_b64_tr_b16 v[36:37], v4 offset:11264
    ds_read_b64_tr_b16 v[38:39], v4 offset:11776
    s_waitcnt lgkmcnt(12)
    v_mfma_f32_32x32x16_bf16 v[136:151], v[8:11], v[56:59], v[136:151]
    v_mfma_f32_32x32x16_bf16 v[152:167], v[12:15], v[56:59], v[152:167]
    s_waitcnt lgkmcnt(8)
    v_mfma_f32_32x32x16_bf16 v[136:151], v[16:19], v[60:63], v[136:151]
    v_mfma_f32_32x32x16_bf16 v[152:167], v[20:23], v[60:63], v[152:167]
    s_waitcnt lgkmcnt(4)
    v_mfma_f32_32x32x16_bf16 v[136:151], v[24:27], v[64:67], v[136:151]
    v_mfma_f32_32x32x16_bf16 v[152:167], v[28:31], v[64:67], v[152:167]
    s_waitcnt lgkmcnt(0)
    v_mfma_f32_32x32x16_bf16 v[136:151], v[32:35], v[68:71], v[136:151]
    v_mfma_f32_32x32x16_bf16 v[152:167], v[36:39], v[68:71], v[152:167]
    s_cmp_gt_u32 s4, 3
    s_cbranch_scc1 w4_10030
    s_waitcnt vmcnt(24)
    s_branch wj_10031
w4_10030:
    s_waitcnt vmcnt(16)
wj_10031:
    s_barrier
    s_cmp_gt_u32 s4, 3
    s_cbranch_scc1 nodma_10032
    s_add_u32 m0, s20, 8192
    s_add_u32 s21, s22, 851968
    buffer_load_dwordx4 v1, s[12:15], s21 offen lds
    s_add_u32 s21, s21, 7168
    buffer_load_dwordx4 v1, s[12:15], s21 offen offset:1024 lds
nodma_10032:
    s_mov_b32 s21, 53248
    buffer_load_dwordx4 v[56:59], v2, s[8:11], s21 offen offset:0
    buffer_load_dwordx4 v[60:63], v2, s[8:11], s21 offen offset:1024
    buffer_load_dwordx4 v[64:67], v2, s[8:11], s21 offen offset:2048
    buffer_load_dwordx4 v[68:71], v2, s[8:11], s21 offen offset:3072
    ds_read_b64_tr_b16 v[8:9], v3 offset:16384
    ds_read_b64_tr_b16 v[10:11], v3 offset:16896
    ds_read_b64_tr_b16 v[12:13], v4 offset:16384
    ds_read_b64_tr_b16 v[14:15], v4 offset:16896
    ds_read_b64_tr_b16 v[16:17], v3 offset:17408
    ds_read_b64_tr_b16 v[18:19], v3 offset:17920
    ds_read_b64_tr_b16 v[20:21], v4 offset:17408
    ds_read_b64_tr_b16 v[22:23], v4 offset:17920
    ds_read_b64_tr_b16 v[24:25], v3 offset:18432
    ds_read_b64_tr_b16 v[26:27], v3 offset:18944
    ds_read_b64_tr_b16 v[28:29], v4 offset:18432
    ds_read_b64_tr_b16 v[30:31], v4 offset:18944
    ds_read_b64_tr_b16 v[32:33], v3 offset:19456
    ds_read_b64_tr_b16 v[34:35], v3 offset:19968
    ds_read_b64_tr_b16 v[36:37], v4 offset:19456
    ds_read_b64_tr_b16 v[38:39], v4 offset:19968
    s_waitcnt lgkmcnt(12)
    v_mfma_f32_32x32x16_bf16 v[136:151], v[8:11], v[72:75], v[136:151]
    v_mfma_f32_32x32x16_bf16 v[152:167], v[12:15], v[72:75], v[152:167]
    s_waitcnt lgkmcnt(8)
    v_mfma_f32_32x32x16_bf16 v[136:151], v[16:19], v[76:79], v[136:151]
    v_mfma_f32_32x32x16_bf16 v[152:167], v[20:23], v[76:79], v[152:167]
    s_waitcnt lgkmcnt(4)
    v_mfma_f32_32x32x16_bf16 v[136:151], v[24:27], v[80:83], v[136:151]
    v_mfma_f32_32x32x16_bf16 v[152:167], v[28:31], v[80:83], v[152:167]
    s_waitcnt lgkmcnt(0)
    v_mfma_f32_32x32x16_bf16 v[136:151], v[32:35], v[84:87], v[136:151]
    v_mfma_f32_32x32x16_bf16 v[152:167], v[36:39], v[84:87], v[152:167]
    s_cmp_gt_u32 s4, 3
    s_cbranch_scc1 w4_10033
    s_waitcnt vmcnt(24)
    s_branch wj_10034
w4_10033:
    s_waitcnt vmcnt(16)
wj_10034:
    s_barrier
    s_cmp_gt_u32 s4, 3
    s_cbranch_scc1 nodma_10035
    s_add_u32 m0, s20, 16384
    s_add_u32 s21, s22, 917504
    buffer_load_dwordx4 v1, s[12:15], s21 offen lds
    s_add_u32 s21, s21, 7168
    buffer_load_dwordx4 v1, s[12:15], s21 offen offset:1024 lds
nodma_10035:
    s_mov_b32 s21, 57344
    buffer_load_dwordx4 v[72:75], v2, s[8:11], s21 offen offset:0
    buffer_load_dwordx4 v[76:79], v2, s[8:11], s21 offen offset:1024
    buffer_load_dwordx4 v[80:83], v2, s[8:11], s21 offen offset:2048
    buffer_load_dwordx4 v[84:87], v2, s[8:11], s21 offen offset:3072
    ds_read_b64_tr_b16 v[8:9], v3 offset:24576
    ds_read_b64_tr_b16 v[10:11], v3 offset:25088
    ds_read_b64_tr_b16 v[12:13], v4 offset:24576
    ds_read_b64_tr_b16 v[14:15], v4 offset:25088
    ds_read_b64_tr_b16 v[16:17], v3 offset:25600
    ds_read_b64_tr_b16 v[18:19], v3 offset:26112
    ds_read_b64_tr_b16 v[20:21], v4 offset:25600
    ds_read_b64_tr_b16 v[22:23], v4 offset:26112
    ds_read_b64_tr_b16 v[24:25], v3 offset:26624
    ds_read_b64_tr_b16 v[26:27], v3 offset:27136
    ds_read_b64_tr_b16 v[28:29], v4 offset:26624
    ds_read_b64_tr_b16 v[30:31], v4 offset:27136
    ds_read_b64_tr_b16 v[32:33], v3 offset:27648
    ds_read_b64_tr_b16 v[34:35], v3 offset:28160
    ds_read_b64_tr_b16 v[36:37], v4 offset:27648
    ds_read_b64_tr_b16 v[38:39], v4 offset:28160
    s_waitcnt lgkmcnt(12)
    v_mfma_f32_32x32x16_bf16 v[136:151], v[8:11], v[88:91], v[136:151]
    v_mfma_f32_32x32x16_bf16 v[152:167], v[12:15], v[88:91], v[152:167]
    s_waitcnt lgkmcnt(8)
    v_mfma_f32_32x32x16_bf16 v[136:151], v[16:19], v[92:95], v[136:151]
    v_mfma_f32_32x32x16_bf16 v[152:167], v[20:23], v[92:95], v[152:167]
    s_waitcnt lgkmcnt(4)
    v_mfma_f32_32x32x16_bf16 v[136:151], v[24:27], v[96:99], v[136:151]
    v_mfma_f32_32x32x16_bf16 v[152:167], v[28:31], v[96:99], v[152:167]
    s_waitcnt lgkmcnt(0)
    v_mfma_f32_32x32x16_bf16 v[136:151], v[32:35], v[100:103], v[136:151]
    v_mfma_f32_32x32x16_bf16 v[152:167], v[36:39], v[100:103], v[152:167]
    s_cmp_gt_u32 s4, 3
    s_cbranch_scc1 w4_10036
    s_waitcnt vmcnt(24)
    s_branch wj_10037
w4_10036:
    s_waitcnt vmcnt(16)
wj_10037:
    s_barrier
    s_cmp_gt_u32 s4, 3
    s_cbranch_scc1 nodma_10038
    s_add_u32 m0, s20, 24576
    s_add_u32 s21, s22, 983040
    buffer_load_dwordx4 v1, s[12:15], s21 offen lds
    s_add_u32 s21, s21, 7168
    buffer_load_dwordx4 v1, s[12:15], s21 offen offset:1024 lds
nodma_10038:
    s_mov_b32 s21, 61440
    buffer_load_dwordx4 v[88:91], v2, s[8:11], s21 offen offset:0
    buffer_load_dwordx4 v[92:95], v2, s[8:11], s21 offen offset:1024
    buffer_load_dwordx4 v[96:99], v2, s[8:11], s21 offen offset:2048
    buffer_load_dwordx4 v[100:103], v2, s[8:11], s21 offen offset:3072
    ds_read_b64_tr_b16 v[8:9], v3 offset:32768
    ds_read_b64_tr_b16 v[10:11], v3 offset:33280
    ds_read_b64_tr_b16 v[12:13], v4 offset:32768
    ds_read_b64_tr_b16 v[14:15], v4 offset:33280
    ds_read_b64_tr_b16 v[16:17], v3 offset:33792
    ds_read_b64_tr_b16 v[18:19], v3 offset:34304
    ds_read_b64_tr_b16 v[20:21], v4 offset:33792
    ds_read_b64_tr_b16 v[22:23], v4 offset:34304
    ds_read_b64_tr_b16 v[24:25], v3 offset:34816
    ds_read_b64_tr_b16 v[26:27], v3 offset:35328
    ds_read_b64_tr_b16 v[28:29], v4 offset:34816
    ds_read_b64_tr_b16 v[30:31], v4 offset:35328
    ds_read_b64_tr_b16 v[32:33], v3 offset:35840
    ds_read_b64_tr_b16 v[34:35], v3 offset:36352
    ds_read_b64_tr_b16 v[36:37], v4 offset:35840
    ds_read_b64_tr_b16 v[38:39], v4 offset:36352
    s_waitcnt lgkmcnt(12)
    v_mfma_f32_32x32x16_bf16 v[136:151], v[8:11], v[104:107], v[136:151]
    v_mfma_f32_32x32x16_bf16 v[152:167], v[12:15], v[104:107], v[152:167]
    s_waitcnt lgkmcnt(8)
    v_mfma_f32_32x32x16_bf16 v[136:151], v[16:19], v[108:111], v[136:151]
    v_mfma_f32_32x32x16_bf16 v[152:167], v[20:23], v[108:111], v[152:167]
    s_waitcnt lgkmcnt(4)
    v_mfma_f32_32x32x16_bf16 v[136:151], v[24:27], v[112:115], v[136:151]
    v_mfma_f32_32x32x16_bf16 v[152:167], v[28:31], v[112:115], v[152:167]
    s_waitcnt lgkmcnt(0)
    v_mfma_f32_32x32x16_bf16 v[136:151], v[32:35], v[116:119], v[136:151]
    v_mfma_f32_32x32x16_bf16 v[152:167], v[36:39], v[116:119], v[152:167]
    s_cmp_gt_u32 s4, 3
    s_cbranch_scc1 w4_10039
    s_waitcnt vmcnt(24)
    s_branch wj_10040
w4_10039:
    s_waitcnt vmcnt(16)
wj_10040:
    s_barrier
    s_cmp_gt_u32 s4, 3
    s_cbranch_scc1 nodma_10041
    s_add_u32 m0, s20, 32768
    s_add_u32 s21, s22, 1048576
    buffer_load_dwordx4 v1, s[12:15], s21 offen lds
    s_add_u32 s21, s21, 7168
    buffer_load_dwordx4 v1, s[12:15], s21 offen offset:1024 lds
nodma_10041:
    s_mov_b32 s21, 65536
    buffer_load_dwordx4 v[104:107], v2, s[8:11], s21 offen offset:0
    buffer_load_dwordx4 v[108:111], v2, s[8:11], s21 offen offset:1024
    buffer_load_dwordx4 v[112:115], v2, s[8:11], s21 offen offset:2048
    buffer_load_dwordx4 v[116:119], v2, s[8:11], s21 offen offset:3072
    ds_read_b64_tr_b16 v[8:9], v3 offset:40960
    ds_read_b64_tr_b16 v[10:11], v3 offset:41472
    ds_read_b64_tr_b16 v[12:13], v4 offset:40960
    ds_read_b64_tr_b16 v[14:15], v4 offset:41472
    ds_read_b64_tr_b16 v[16:17], v3 offset:41984
    ds_read_b64_tr_b16 v[18:19], v3 offset:42496
    ds_read_b64_tr_b16 v[20:21], v4 offset:41984
    ds_read_b64_tr_b16 v[22:23], v4 offset:42496
    ds_read_b64_tr_b16 v[24:25], v3 offset:43008
    ds_read_b64_tr_b16 v[26:27], v3 offset:43520
    ds_read_b64_tr_b16 v[28:29], v4 offset:43008
    ds_read_b64_tr_b16 v[30:31], v4 offset:43520
    ds_read_b64_tr_b16 v[32:33], v3 offset:44032
    ds_read_b64_tr_b16 v[34:35], v3 offset:44544
    ds_read_b64_tr_b16 v[36:37], v4 offset:44032
    ds_read_b64_tr_b16 v[38:39], v4 offset:44544
    s_waitcnt lgkmcnt(12)
    v_mfma_f32_32x32x16_bf16 v[136:151], v[8:11], v[120:123], v[136:151]
    v_mfma_f32_32x32x16_bf16 v[152:167], v[12:15], v[120:123], v[152:167]
    s_waitcnt lgkmcnt(8)
    v_mfma_f32_32x32x16_bf16 v[136:151], v[16:19], v[124:127], v[136:151]
    v_mfma_f32_32x32x16_bf16 v[152:167], v[20:23], v[124:127], v[152:167]
    s_waitcnt lgkmcnt(4)
    v_mfma_f32_32x32x16_bf16 v[136:151], v[24:27], v[128:131], v[136:151]
    v_mfma_f32_32x32x16_bf16 v[152:167], v[28:31], v[128:131], v[152:167]
    s_waitcnt lgkmcnt(0)
    v_mfma_f32_32x32x16_bf16 v[136:151], v[32:35], v[132:135], v[136:151]
    v_mfma_f32_32x32x16_bf16 v[152:167], v[36:39], v[132:135], v[152:167]
    s_cmp_gt_u32 s4, 3
    s_cbranch_scc1 w4_10042
    s_waitcnt vmcnt(24)
    s_branch wj_10043
w4_10042:
    s_waitcnt vmcnt(16)
wj_10043:
    s_barrier
    s_cmp_gt_u32 s4, 3
    s_cbranch_scc1 nodma_10044
    s_add_u32 m0, s20, 40960
    s_add_u32 s21, s22, 1114112
    buffer_load_dwordx4 v1, s[12:15], s21 offen lds
    s_add_u32 s21, s21, 7168
    buffer_load_dwordx4 v1, s[12:15], s21 offen offset:1024 lds
nodma_10044:
    s_mov_b32 s21, 69632
    buffer_load_dwordx4 v[120:123], v2, s[8:11], s21 offen offset:0
    buffer_load_dwordx4 v[124:127], v2, s[8:11], s21 offen offset:1024
    buffer_load_dwordx4 v[128:131], v2, s[8:11], s21 offen offset:2048
    buffer_load_dwordx4 v[132:135], v2, s[8:11], s21 offen offset:3072
    ds_read_b64_tr_b16 v[8:9], v3 offset:0
    ds_read_b64_tr_b16 v[10:11], v3 offset:512
    ds_read_b64_tr_b16 v[12:13], v4 offset:0
    ds_read_b64_tr_b16 v[14:15], v4 offset:512
    ds_read_b64_tr_b16 v[16:17], v3 offset:1024
    ds_read_b64_tr_b16 v[18:19], v3 offset:1536
    ds_read_b64_tr_b16 v[20:21], v4 offset:1024
    ds_read_b64_tr_b16 v[22:23], v4 offset:1536
    ds_read_b64_tr_b16 v[24:25], v3 offset:2048
    ds_read_b64_tr_b16 v[26:27], v3 offset:2560
    ds_read_b64_tr_b16 v[28:29], v4 offset:2048
    ds_read_b64_tr_b16 v[30:31], v4 offset:2560
    ds_read_b64_tr_b16 v[32:33], v3 offset:3072
    ds_read_b64_tr_b16 v[34:35], v3 offset:3584
    ds_read_b64_tr_b16 v[36:37], v4 offset:3072
    ds_read_b64_tr_b16 v[38:39], v4 offset:3584
    s_waitcnt lgkmcnt(12)
    v_mfma_f32_32x32x16_bf16 v[136:151], v[8:11], v[40:43], v[136:151]
    v_mfma_f32_32x32x16_bf16 v[152:167], v[12:15], v[40:43], v[152:167]
    s_waitcnt lgkmcnt(8)
    v_mfma_f32_32x32x16_bf16 v[136:151], v[16:19], v[44:47], v[136:151]
    v_mfma_f32_32x32x16_bf16 v[152:167], v[20:23], v[44:47], v[152:167]
    s_waitcnt lgkmcnt(4)
    v_mfma_f32_32x32x16_bf16 v[136:151], v[24:27], v[48:51], v[136:151]
    v_mfma_f32_32x32x16_bf16 v[152:167], v[28:31], v[48:51], v[152:167]
    s_waitcnt lgkmcnt(0)
    v_mfma_f32_32x32x16_bf16 v[136:151], v[32:35], v[52:55], v[136:151]
    v_mfma_f32_32x32x16_bf16 v[152:167], v[36:39], v[52:55], v[152:167]
    s_cmp_gt_u32 s4, 3
    s_cbranch_scc1 w4_10045
    s_waitcnt vmcnt(24)
    s_branch wj_10046
w4_10045:
    s_waitcnt vmcnt(16)
wj_10046:
    s_barrier
    s_cmp_gt_u32 s4, 3
    s_cbranch_scc1 nodma_10047
    s_add_u32 m0, s20, 0
    s_add_u32 s21, s22, 1179648
    buffer_load_dwordx4 v1, s[12:15], s21 offen lds
    s_add_u32 s21, s21, 7168
    buffer_load_dwordx4 v1, s[12:15], s21 offen offset:1024 lds
nodma_10047:
    s_mov_b32 s21, 73728
    buffer_load_dwordx4 v[40:43], v2, s[8:11], s21 offen offset:0
    buffer_load_dwordx4 v[44:47], v2, s[8:11], s21 offen offset:1024
    buffer_load_dwordx4 v[48:51], v2, s[8:11], s21 offen offset:2048
    buffer_load_dwordx4 v[52:55], v2, s[8:11], s21 offen offset:3072
    ds_read_b64_tr_b16 v[8:9], v3 offset:8192
    ds_read_b64_tr_b16 v[10:11], v3 offset:8704
    ds_read_b64_tr_b16 v[12:13], v4 offset:8192
    ds_read_b64_tr_b16 v[14:15], v4 offset:8704
    ds_read_b64_tr_b16 v[16:17], v3 offset:9216
    ds_read_b64_tr_b16 v[18:19], v3 offset:9728
    ds_read_b64_tr_b16 v[20:21], v4 offset:9216
    ds_read_b64_tr_b16 v[22:23], v4 offset:9728
    ds_read_b64_tr_b16 v[24:25], v3 offset:10240
    ds_read_b64_tr_b16 v[26:27], v3 offset:10752
    ds_read_b64_tr_b16 v[28:29], v4 offset:10240
    ds_read_b64_tr_b16 v[30:31], v4 offset:10752
    ds_read_b64_tr_b16 v[32:33], v3 offset:11264
    ds_read_b64_tr_b16 v[34:35], v3 offset:11776
    ds_read_b64_tr_b16 v[36:37], v4 offset:11264
    ds_read_b64_tr_b16 v[38:39], v4 offset:11776
    s_waitcnt lgkmcnt(12)
    v_mfma_f32_32x32x16_bf16 v[136:151], v[8:11], v[56:59], v[136:151]
    v_mfma_f32_32x32x16_bf16 v[152:167], v[12:15], v[56:59], v[152:167]
    s_waitcnt lgkmcnt(8)
    v_mfma_f32_32x32x16_bf16 v[136:151], v[16:19], v[60:63], v[136:151]
    v_mfma_f32_32x32x16_bf16 v[152:167], v[20:23], v[60:63], v[152:167]
    s_waitcnt lgkmcnt(4)
    v_mfma_f32_32x32x16_bf16 v[136:151], v[24:27], v[64:67], v[136:151]
    v_mfma_f32_32x32x16_bf16 v[152:167], v[28:31], v[64:67], v[152:167]
    s_waitcnt lgkmcnt(0)
    v_mfma_f32_32x32x16_bf16 v[136:151], v[32:35], v[68:71], v[136:151]
    v_mfma_f32_32x32x16_bf16 v[152:167], v[36:39], v[68:71], v[152:167]
    s_cmp_gt_u32 s4, 3
    s_cbranch_scc1 w4_10048
    s_waitcnt vmcnt(24)
    s_branch wj_10049
w4_10048:
    s_waitcnt vmcnt(16)
wj_10049:
    s_barrier
    s_cmp_gt_u32 s4, 3
    s_cbranch_scc1 nodma_10050
    s_add_u32 m0, s20, 8192
    s_add_u32 s21, s22, 1245184
    buffer_load_dwordx4 v1, s[12:15], s21 offen lds
    s_add_u32 s21, s21, 7168
    buffer_load_dwordx4 v1, s[12:15], s21 offen offset:1024 lds
nodma_10050:
    s_mov_b32 s21, 77824
    buffer_load_dwordx4 v[56:59], v2, s[8:11], s21 offen offset:0
    buffer_load_dwordx4 v[60:63], v2, s[8:11], s21 offen offset:1024
    buffer_load_dwordx4 v[64:67], v2, s[8:11], s21 offen offset:2048
    buffer_load_dwordx4 v[68:71], v2, s[8:11], s21 offen offset:3072
    ds_read_b64_tr_b16 v[8:9], v3 offset:16384
    ds_read_b64_tr_b16 v[10:11], v3 offset:16896
    ds_read_b64_tr_b16 v[12:13], v4 offset:16384
    ds_read_b64_tr_b16 v[14:15], v4 offset:16896
    ds_read_b64_tr_b16 v[16:17], v3 offset:17408
    ds_read_b64_tr_b16 v[18:19], v3 offset:17920
    ds_read_b64_tr_b16 v[20:21], v4 offset:17408
    ds_read_b64_tr_b16 v[22:23], v4 offset:17920
    ds_read_b64_tr_b16 v[24:25], v3 offset:18432
    ds_read_b64_tr_b16 v[26:27], v3 offset:18944
    ds_read_b64_tr_b16 v[28:29], v4 offset:18432
    ds_read_b64_tr_b16 v[30:31], v4 offset:18944
    ds_read_b64_tr_b16 v[32:33], v3 offset:19456
    ds_read_b64_tr_b16 v[34:35], v3 offset:19968
    ds_read_b64_tr_b16 v[36:37], v4 offset:19456
    ds_read_b64_tr_b16 v[38:39], v4 offset:19968
    s_waitcnt lgkmcnt(12)
    v_mfma_f32_32x32x16_bf16 v[136:151], v[8:11], v[72:75], v[136:151]
    v_mfma_f32_32x32x16_bf16 v[152:167], v[12:15], v[72:75], v[152:167]
    s_waitcnt lgkmcnt(8)
    v_mfma_f32_32x32x16_bf16 v[136:151], v[16:19], v[76:79], v[136:151]
    v_mfma_f32_32x32x16_bf16 v[152:167], v[20:23], v[76:79], v[152:167]
    s_waitcnt lgkmcnt(4)
    v_mfma_f32_32x32x16_bf16 v[136:151], v[24:27], v[80:83], v[136:151]
    v_mfma_f32_32x32x16_bf16 v[152:167], v[28:31], v[80:83], v[152:167]
    s_waitcnt lgkmcnt(0)
    v_mfma_f32_32x32x16_bf16 v[136:151], v[32:35], v[84:87], v[136:151]
    v_mfma_f32_32x32x16_bf16 v[152:167], v[36:39], v[84:87], v[152:167]
    s_cmp_gt_u32 s4, 3
    s_cbranch_scc1 w4_10051
    s_waitcnt vmcnt(24)
    s_branch wj_10052
w4_10051:
    s_waitcnt vmcnt(16)
wj_10052:
    s_barrier
    s_cmp_gt_u32 s4, 3
    s_cbranch_scc1 nodma_10053
    s_add_u32 m0, s20, 16384
    s_add_u32 s21, s22, 1310720
    buffer_load_dwordx4 v1, s[12:15], s21 offen lds
    s_add_u32 s21, s21, 7168
    buffer_load_dwordx4 v1, s[12:15], s21 offen offset:1024 lds
nodma_10053:
    s_mov_b32 s21, 81920
    buffer_load_dwordx4 v[72:75], v2, s[8:11], s21 offen offset:0
    buffer_load_dwordx4 v[76:79], v2, s[8:11], s21 offen offset:1024
    buffer_load_dwordx4 v[80:83], v2, s[8:11], s21 offen offset:2048
    buffer_load_dwordx4 v[84:87], v2, s[8:11], s21 offen offset:3072
    ds_read_b64_tr_b16 v[8:9], v3 offset:24576
    ds_read_b64_tr_b16 v[10:11], v3 offset:25088
    ds_read_b64_tr_b16 v[12:13], v4 offset:24576
    ds_read_b64_tr_b16 v[14:15], v4 offset:25088
    ds_read_b64_tr_b16 v[16:17], v3 offset:25600
    ds_read_b64_tr_b16 v[18:19], v3 offset:26112
    ds_read_b64_tr_b16 v[20:21], v4 offset:25600
    ds_read_b64_tr_b16 v[22:23], v4 offset:26112
    ds_read_b64_tr_b16 v[24:25], v3 offset:26624
    ds_read_b64_tr_b16 v[26:27], v3 offset:27136
    ds_read_b64_tr_b16 v[28:29], v4 offset:26624
    ds_read_b64_tr_b16 v[30:31], v4 offset:27136
    ds_read_b64_tr_b16 v[32:33], v3 offset:27648
    ds_read_b64_tr_b16 v[34:35], v3 offset:28160
    ds_read_b64_tr_b16 v[36:37], v4 offset:27648
    ds_read_b64_tr_b16 v[38:39], v4 offset:28160
    s_waitcnt lgkmcnt(12)
    v_mfma_f32_32x32x16_bf16 v[136:151], v[8:11], v[88:91], v[136:151]
    v_mfma_f32_32x32x16_bf16 v[152:167], v[12:15], v[88:91], v[152:167]
    s_waitcnt lgkmcnt(8)
    v_mfma_f32_32x32x16_bf16 v[136:151], v[16:19], v[92:95], v[136:151]
    v_mfma_f32_32x32x16_bf16 v[152:167], v[20:23], v[92:95], v[152:167]
    s_waitcnt lgkmcnt(4)
    v_mfma_f32_32x32x16_bf16 v[136:151], v[24:27], v[96:99], v[136:151]
    v_mfma_f32_32x32x16_bf16 v[152:167], v[28:31], v[96:99], v[152:167]
    s_waitcnt lgkmcnt(0)
    v_mfma_f32_32x32x16_bf16 v[136:151], v[32:35], v[100:103], v[136:151]
    v_mfma_f32_32x32x16_bf16 v[152:167], v[36:39], v[100:103], v[152:167]
    s_cmp_gt_u32 s4, 3
    s_cbranch_scc1 w4_10054
    s_waitcnt vmcnt(24)
    s_branch wj_10055
w4_10054:
    s_waitcnt vmcnt(16)
wj_10055:
    s_barrier
    s_cmp_gt_u32 s4, 3
    s_cbranch_scc1 nodma_10056
    s_add_u32 m0, s20, 24576
    s_add_u32 s21, s22, 1376256
    buffer_load_dwordx4 v1, s[12:15], s21 offen lds
    s_add_u32 s21, s21, 7168
    buffer_load_dwordx4 v1, s[12:15], s21 offen offset:1024 lds
nodma_10056:
    s_mov_b32 s21, 86016
    buffer_load_dwordx4 v[88:91], v2, s[8:11], s21 offen offset:0
    buffer_load_dwordx4 v[92:95], v2, s[8:11], s21 offen offset:1024
    buffer_load_dwordx4 v[96:99], v2, s[8:11], s21 offen offset:2048
    buffer_load_dwordx4 v[100:103], v2, s[8:11], s21 offen offset:3072
    ds_read_b64_tr_b16 v[8:9], v3 offset:32768
    ds_read_b64_tr_b16 v[10:11], v3 offset:33280
    ds_read_b64_tr_b16 v[12:13], v4 offset:32768
    ds_read_b64_tr_b16 v[14:15], v4 offset:33280
    ds_read_b64_tr_b16 v[16:17], v3 offset:33792
    ds_read_b64_tr_b16 v[18:19], v3 offset:34304
    ds_read_b64_tr_b16 v[20:21], v4 offset:33792
    ds_read_b64_tr_b16 v[22:23], v4 offset:34304
    ds_read_b64_tr_b16 v[24:25], v3 offset:34816
    ds_read_b64_tr_b16 v[26:27], v3 offset:35328
    ds_read_b64_tr_b16 v[28:29], v4 offset:34816
    ds_read_b64_tr_b16 v[30:31], v4 offset:35328
    ds_read_b64_tr_b16 v[32:33], v3 offset:35840
    ds_read_b64_tr_b16 v[34:35], v3 offset:36352
    ds_read_b64_tr_b16 v[36:37], v4 offset:35840
    ds_read_b64_tr_b16 v[38:39], v4 offset:36352
    s_waitcnt lgkmcnt(12)
    v_mfma_f32_32x32x16_bf16 v[136:151], v[8:11], v[104:107], v[136:151]
    v_mfma_f32_32x32x16_bf16 v[152:167], v[12:15], v[104:107], v[152:167]
    s_waitcnt lgkmcnt(8)
    v_mfma_f32_32x32x16_bf16 v[136:151], v[16:19], v[108:111], v[136:151]
    v_mfma_f32_32x32x16_bf16 v[152:167], v[20:23], v[108:111], v[152:167]
    s_waitcnt lgkmcnt(4)
    v_mfma_f32_32x32x16_bf16 v[136:151], v[24:27], v[112:115], v[136:151]
    v_mfma_f32_32x32x16_bf16 v[152:167], v[28:31], v[112:115], v[152:167]
    s_waitcnt lgkmcnt(0)
    v_mfma_f32_32x32x16_bf16 v[136:151], v[32:35], v[116:119], v[136:151]
    v_mfma_f32_32x32x16_bf16 v[152:167], v[36:39], v[116:119], v[152:167]
    s_cmp_gt_u32 s4, 3
    s_cbranch_scc1 w4_10057
    s_waitcnt vmcnt(24)
    s_branch wj_10058
w4_10057:
    s_waitcnt vmcnt(16)
wj_10058:
    s_barrier
    s_cmp_gt_u32 s4, 3
    s_cbranch_scc1 nodma_10059
    s_add_u32 m0, s20, 32768
    s_add_u32 s21, s22, 1441792
    buffer_load_dwordx4 v1, s[12:15], s21 offen lds
    s_add_u32 s21, s21, 7168
    buffer_load_dwordx4 v1, s[12:15], s21 offen offset:1024 lds
nodma_10059:
    s_mov_b32 s21, 90112
    buffer_load_dwordx4 v[104:107], v2, s[8:11], s21 offen offset:0
    buffer_load_dwordx4 v[108:111], v2, s[8:11], s21 offen offset:1024
    buffer_load_dwordx4 v[112:115], v2, s[8:11], s21 offen offset:2048
    buffer_load_dwordx4 v[116:119], v2, s[8:11], s21 offen offset:3072
    ds_read_b64_tr_b16 v[8:9], v3 offset:40960
    ds_read_b64_tr_b16 v[10:11], v3 offset:41472
    ds_read_b64_tr_b16 v[12:13], v4 offset:40960
    ds_read_b64_tr_b16 v[14:15], v4 offset:41472
    ds_read_b64_tr_b16 v[16:17], v3 offset:41984
    ds_read_b64_tr_b16 v[18:19], v3 offset:42496
    ds_read_b64_tr_b16 v[20:21], v4 offset:41984
    ds_read_b64_tr_b16 v[22:23], v4 offset:42496
    ds_read_b64_tr_b16 v[24:25], v3 offset:43008
    ds_read_b64_tr_b16 v[26:27], v3 offset:43520
    ds_read_b64_tr_b16 v[28:29], v4 offset:43008
    ds_read_b64_tr_b16 v[30:31], v4 offset:43520
    ds_read_b64_tr_b16 v[32:33], v3 offset:44032
    ds_read_b64_tr_b16 v[34:35], v3 offset:44544
    ds_read_b64_tr_b16 v[36:37], v4 offset:44032
    ds_read_b64_tr_b16 v[38:39], v4 offset:44544
    s_waitcnt lgkmcnt(12)
    v_mfma_f32_32x32x16_bf16 v[136:151], v[8:11], v[120:123], v[136:151]
    v_mfma_f32_32x32x16_bf16 v[152:167], v[12:15], v[120:123], v[152:167]
    s_waitcnt lgkmcnt(8)
    v_mfma_f32_32x32x16_bf16 v[136:151], v[16:19], v[124:127], v[136:151]
    v_mfma_f32_32x32x16_bf16 v[152:167], v[20:23], v[124:127], v[152:167]
    s_waitcnt lgkmcnt(4)
    v_mfma_f32_32x32x16_bf16 v[136:151], v[24:27], v[128:131], v[136:151]
    v_mfma_f32_32x32x16_bf16 v[152:167], v[28:31], v[128:131], v[152:167]
    s_waitcnt lgkmcnt(0)
    v_mfma_f32_32x32x16_bf16 v[136:151], v[32:35], v[132:135], v[136:151]
    v_mfma_f32_32x32x16_bf16 v[152:167], v[36:39], v[132:135], v[152:167]
    s_cmp_gt_u32 s4, 3
    s_cbranch_scc1 w4_10060
    s_waitcnt vmcnt(24)
    s_branch wj_10061
w4_10060:
    s_waitcnt vmcnt(16)
wj_10061:
    s_barrier
    s_cmp_gt_u32 s4, 3
    s_cbranch_scc1 nodma_10062
    s_add_u32 m0, s20, 40960
    s_add_u32 s21, s22, 1507328
    buffer_load_dwordx4 v1, s[12:15], s21 offen lds
    s_add_u32 s21, s21, 7168
    buffer_load_dwordx4 v1, s[12:15], s21 offen offset:1024 lds
nodma_10062:
    s_mov_b32 s21, 94208
    buffer_load_dwordx4 v[120:123], v2, s[8:11], s21 offen offset:0
    buffer_load_dwordx4 v[124:127], v2, s[8:11], s21 offen offset:1024
    buffer_load_dwordx4 v[128:131], v2, s[8:11], s21 offen offset:2048
    buffer_load_dwordx4 v[132:135], v2, s[8:11], s21 offen offset:3072
    ds_read_b64_tr_b16 v[8:9], v3 offset:0
    ds_read_b64_tr_b16 v[10:11], v3 offset:512
    ds_read_b64_tr_b16 v[12:13], v4 offset:0
    ds_read_b64_tr_b16 v[14:15], v4 offset:512
    ds_read_b64_tr_b16 v[16:17], v3 offset:1024
    ds_read_b64_tr_b16 v[18:19], v3 offset:1536
    ds_read_b64_tr_b16 v[20:21], v4 offset:1024
    ds_read_b64_tr_b16 v[22:23], v4 offset:1536
    ds_read_b64_tr_b16 v[24:25], v3 offset:2048
    ds_read_b64_tr_b16 v[26:27], v3 offset:2560
    ds_read_b64_tr_b16 v[28:29], v4 offset:2048
    ds_read_b64_tr_b16 v[30:31], v4 offset:2560
    ds_read_b64_tr_b16 v[32:33], v3 offset:3072
    ds_read_b64_tr_b16 v[34:35], v3 offset:3584
    ds_read_b64_tr_b16 v[36:37], v4 offset:3072
    ds_read_b64_tr_b16 v[38:39], v4 offset:3584
    s_waitcnt lgkmcnt(12)
    v_mfma_f32_32x32x16_bf16 v[136:151], v[8:11], v[40:43], v[136:151]
    v_mfma_f32_32x32x16_bf16 v[152:167], v[12:15], v[40:43], v[152:167]
    s_waitcnt lgkmcnt(8)
    v_mfma_f32_32x32x16_bf16 v[136:151], v[16:19], v[44:47], v[136:151]
    v_mfma_f32_32x32x16_bf16 v[152:167], v[20:23], v[44:47], v[152:167]
    s_waitcnt lgkmcnt(4)
    v_mfma_f32_32x32x16_bf16 v[136:151], v[24:27], v[48:51], v[136:151]
    v_mfma_f32_32x32x16_bf16 v[152:167], v[28:31], v[48:51], v[152:167]
    s_waitcnt lgkmcnt(0)
    v_mfma_f32_32x32x16_bf16 v[136:151], v[32:35], v[52:55], v[136:151]
    v_mfma_f32_32x32x16_bf16 v[152:167], v[36:39], v[52:55], v[152:167]
    s_cmp_gt_u32 s4, 3
    s_cbranch_scc1 w4_10063
    s_waitcnt vmcnt(24)
    s_branch wj_10064
w4_10063:
    s_waitcnt vmcnt(16)
wj_10064:
    s_barrier
    s_cmp_gt_u32 s4, 3
    s_cbranch_scc1 nodma_10065
    s_add_u32 m0, s20, 0
    s_add_u32 s21, s22, 1572864
    buffer_load_dwordx4 v1, s[12:15], s21 offen lds
    s_add_u32 s21, s21, 7168
    buffer_load_dwordx4 v1, s[12:15], s21 offen offset:1024 lds
nodma_10065:
    s_mov_b32 s21, 98304
    buffer_load_dwordx4 v[40:43], v2, s[8:11], s21 offen offset:0
    buffer_load_dwordx4 v[44:47], v2, s[8:11], s21 offen offset:1024
    buffer_load_dwordx4 v[48:51], v2, s[8:11], s21 offen offset:2048
    buffer_load_dwordx4 v[52:55], v2, s[8:11], s21 offen offset:3072
    ds_read_b64_tr_b16 v[8:9], v3 offset:8192
    ds_read_b64_tr_b16 v[10:11], v3 offset:8704
    ds_read_b64_tr_b16 v[12:13], v4 offset:8192
    ds_read_b64_tr_b16 v[14:15], v4 offset:8704
    ds_read_b64_tr_b16 v[16:17], v3 offset:9216
    ds_read_b64_tr_b16 v[18:19], v3 offset:9728
    ds_read_b64_tr_b16 v[20:21], v4 offset:9216
    ds_read_b64_tr_b16 v[22:23], v4 offset:9728
    ds_read_b64_tr_b16 v[24:25], v3 offset:10240
    ds_read_b64_tr_b16 v[26:27], v3 offset:10752
    ds_read_b64_tr_b16 v[28:29], v4 offset:10240
    ds_read_b64_tr_b16 v[30:31], v4 offset:10752
    ds_read_b64_tr_b16 v[32:33], v3 offset:11264
    ds_read_b64_tr_b16 v[34:35], v3 offset:11776
    ds_read_b64_tr_b16 v[36:37], v4 offset:11264
    ds_read_b64_tr_b16 v[38:39], v4 offset:11776
    s_waitcnt lgkmcnt(12)
    v_mfma_f32_32x32x16_bf16 v[136:151], v[8:11], v[56:59], v[136:151]
    v_mfma_f32_32x32x16_bf16 v[152:167], v[12:15], v[56:59], v[152:167]
    s_waitcnt lgkmcnt(8)
    v_mfma_f32_32x32x16_bf16 v[136:151], v[16:19], v[60:63], v[136:151]
    v_mfma_f32_32x32x16_bf16 v[152:167], v[20:23], v[60:63], v[152:167]
    s_waitcnt lgkmcnt(4)
    v_mfma_f32_32x32x16_bf16 v[136:151], v[24:27], v[64:67], v[136:151]
    v_mfma_f32_32x32x16_bf16 v[152:167], v[28:31], v[64:67], v[152:167]
    s_waitcnt lgkmcnt(0)
    v_mfma_f32_32x32x16_bf16 v[136:151], v[32:35], v[68:71], v[136:151]
    v_mfma_f32_32x32x16_bf16 v[152:167], v[36:39], v[68:71], v[152:167]
    s_cmp_gt_u32 s4, 3
    s_cbranch_scc1 w4_10066
    s_waitcnt vmcnt(24)
    s_branch wj_10067
w4_10066:
    s_waitcnt vmcnt(16)
wj_10067:
    s_barrier
    s_cmp_gt_u32 s4, 3
    s_cbranch_scc1 nodma_10068
    s_add_u32 m0, s20, 8192
    s_add_u32 s21, s22, 1638400
    buffer_load_dwordx4 v1, s[12:15], s21 offen lds
    s_add_u32 s21, s21, 7168
    buffer_load_dwordx4 v1, s[12:15], s21 offen offset:1024 lds
nodma_10068:
    s_mov_b32 s21, 102400
    buffer_load_dwordx4 v[56:59], v2, s[8:11], s21 offen offset:0
    buffer_load_dwordx4 v[60:63], v2, s[8:11], s21 offen offset:1024
    buffer_load_dwordx4 v[64:67], v2, s[8:11], s21 offen offset:2048
    buffer_load_dwordx4 v[68:71], v2, s[8:11], s21 offen offset:3072
    ds_read_b64_tr_b16 v[8:9], v3 offset:16384
    ds_read_b64_tr_b16 v[10:11], v3 offset:16896
    ds_read_b64_tr_b16 v[12:13], v4 offset:16384
    ds_read_b64_tr_b16 v[14:15], v4 offset:16896
    ds_read_b64_tr_b16 v[16:17], v3 offset:17408
    ds_read_b64_tr_b16 v[18:19], v3 offset:17920
    ds_read_b64_tr_b16 v[20:21], v4 offset:17408
    ds_read_b64_tr_b16 v[22:23], v4 offset:17920
    ds_read_b64_tr_b16 v[24:25], v3 offset:18432
    ds_read_b64_tr_b16 v[26:27], v3 offset:18944
    ds_read_b64_tr_b16 v[28:29], v4 offset:18432
    ds_read_b64_tr_b16 v[30:31], v4 offset:18944
    ds_read_b64_tr_b16 v[32:33], v3 offset:19456
    ds_read_b64_tr_b16 v[34:35], v3 offset:19968
    ds_read_b64_tr_b16 v[36:37], v4 offset:19456
    ds_read_b64_tr_b16 v[38:39], v4 offset:19968
    s_waitcnt lgkmcnt(12)
    v_mfma_f32_32x32x16_bf16 v[136:151], v[8:11], v[72:75], v[136:151]
    v_mfma_f32_32x32x16_bf16 v[152:167], v[12:15], v[72:75], v[152:167]
    s_waitcnt lgkmcnt(8)
    v_mfma_f32_32x32x16_bf16 v[136:151], v[16:19], v[76:79], v[136:151]
    v_mfma_f32_32x32x16_bf16 v[152:167], v[20:23], v[76:79], v[152:167]
    s_waitcnt lgkmcnt(4)
    v_mfma_f32_32x32x16_bf16 v[136:151], v[24:27], v[80:83], v[136:151]
    v_mfma_f32_32x32x16_bf16 v[152:167], v[28:31], v[80:83], v[152:167]
    s_waitcnt lgkmcnt(0)
    v_mfma_f32_32x32x16_bf16 v[136:151], v[32:35], v[84:87], v[136:151]
    v_mfma_f32_32x32x16_bf16 v[152:167], v[36:39], v[84:87], v[152:167]
    s_cmp_gt_u32 s4, 3
    s_cbranch_scc1 w4_10069
    s_waitcnt vmcnt(24)
    s_branch wj_10070
w4_10069:
    s_waitcnt vmcnt(16)
wj_10070:
    s_barrier
    s_cmp_gt_u32 s4, 3
    s_cbranch_scc1 nodma_10071
    s_add_u32 m0, s20, 16384
    s_add_u32 s21, s22, 1703936
    buffer_load_dwordx4 v1, s[12:15], s21 offen lds
    s_add_u32 s21, s21, 7168
    buffer_load_dwordx4 v1, s[12:15], s21 offen offset:1024 lds
nodma_10071:
    s_mov_b32 s21, 106496
    buffer_load_dwordx4 v[72:75], v2, s[8:11], s21 offen offset:0
    buffer_load_dwordx4 v[76:79], v2, s[8:11], s21 offen offset:1024
    buffer_load_dwordx4 v[80:83], v2, s[8:11], s21 offen offset:2048
    buffer_load_dwordx4 v[84:87], v2, s[8:11], s21 offen offset:3072
    ds_read_b64_tr_b16 v[8:9], v3 offset:24576
    ds_read_b64_tr_b16 v[10:11], v3 offset:25088
    ds_read_b64_tr_b16 v[12:13], v4 offset:24576
    ds_read_b64_tr_b16 v[14:15], v4 offset:25088
    ds_read_b64_tr_b16 v[16:17], v3 offset:25600
    ds_read_b64_tr_b16 v[18:19], v3 offset:26112
    ds_read_b64_tr_b16 v[20:21], v4 offset:25600
    ds_read_b64_tr_b16 v[22:23], v4 offset:26112
    ds_read_b64_tr_b16 v[24:25], v3 offset:26624
    ds_read_b64_tr_b16 v[26:27], v3 offset:27136
    ds_read_b64_tr_b16 v[28:29], v4 offset:26624
    ds_read_b64_tr_b16 v[30:31], v4 offset:27136
    ds_read_b64_tr_b16 v[32:33], v3 offset:27648
    ds_read_b64_tr_b16 v[34:35], v3 offset:28160
    ds_read_b64_tr_b16 v[36:37], v4 offset:27648
    ds_read_b64_tr_b16 v[38:39], v4 offset:28160
    s_waitcnt lgkmcnt(12)
    v_mfma_f32_32x32x16_bf16 v[136:151], v[8:11], v[88:91], v[136:151]
    v_mfma_f32_32x32x16_bf16 v[152:167], v[12:15], v[88:91], v[152:167]
    s_waitcnt lgkmcnt(8)
    v_mfma_f32_32x32x16_bf16 v[136:151], v[16:19], v[92:95], v[136:151]
    v_mfma_f32_32x32x16_bf16 v[152:167], v[20:23], v[92:95], v[152:167]
    s_waitcnt lgkmcnt(4)
    v_mfma_f32_32x32x16_bf16 v[136:151], v[24:27], v[96:99], v[136:151]
    v_mfma_f32_32x32x16_bf16 v[152:167], v[28:31], v[96:99], v[152:167]
    s_waitcnt lgkmcnt(0)
    v_mfma_f32_32x32x16_bf16 v[136:151], v[32:35], v[100:103], v[136:151]
    v_mfma_f32_32x32x16_bf16 v[152:167], v[36:39], v[100:103], v[152:167]
    s_cmp_gt_u32 s4, 3
    s_cbranch_scc1 w4_10072
    s_waitcnt vmcnt(24)
    s_branch wj_10073
w4_10072:
    s_waitcnt vmcnt(16)
wj_10073:
    s_barrier
    s_cmp_gt_u32 s4, 3
    s_cbranch_scc1 nodma_10074
    s_add_u32 m0, s20, 24576
    s_add_u32 s21, s22, 1769472
    buffer_load_dwordx4 v1, s[12:15], s21 offen lds
    s_add_u32 s21, s21, 7168
    buffer_load_dwordx4 v1, s[12:15], s21 offen offset:1024 lds
nodma_10074:
    s_mov_b32 s21, 110592
    buffer_load_dwordx4 v[88:91], v2, s[8:11], s21 offen offset:0
    buffer_load_dwordx4 v[92:95], v2, s[8:11], s21 offen offset:1024
    buffer_load_dwordx4 v[96:99], v2, s[8:11], s21 offen offset:2048
    buffer_load_dwordx4 v[100:103], v2, s[8:11], s21 offen offset:3072
    ds_read_b64_tr_b16 v[8:9], v3 offset:32768
    ds_read_b64_tr_b16 v[10:11], v3 offset:33280
    ds_read_b64_tr_b16 v[12:13], v4 offset:32768
    ds_read_b64_tr_b16 v[14:15], v4 offset:33280
    ds_read_b64_tr_b16 v[16:17], v3 offset:33792
    ds_read_b64_tr_b16 v[18:19], v3 offset:34304
    ds_read_b64_tr_b16 v[20:21], v4 offset:33792
    ds_read_b64_tr_b16 v[22:23], v4 offset:34304
    ds_read_b64_tr_b16 v[24:25], v3 offset:34816
    ds_read_b64_tr_b16 v[26:27], v3 offset:35328
    ds_read_b64_tr_b16 v[28:29], v4 offset:34816
    ds_read_b64_tr_b16 v[30:31], v4 offset:35328
    ds_read_b64_tr_b16 v[32:33], v3 offset:35840
    ds_read_b64_tr_b16 v[34:35], v3 offset:36352
    ds_read_b64_tr_b16 v[36:37], v4 offset:35840
    ds_read_b64_tr_b16 v[38:39], v4 offset:36352
    s_waitcnt lgkmcnt(12)
    v_mfma_f32_32x32x16_bf16 v[136:151], v[8:11], v[104:107], v[136:151]
    v_mfma_f32_32x32x16_bf16 v[152:167], v[12:15], v[104:107], v[152:167]
    s_waitcnt lgkmcnt(8)
    v_mfma_f32_32x32x16_bf16 v[136:151], v[16:19], v[108:111], v[136:151]
    v_mfma_f32_32x32x16_bf16 v[152:167], v[20:23], v[108:111], v[152:167]
    s_waitcnt lgkmcnt(4)
    v_mfma_f32_32x32x16_bf16 v[136:151], v[24:27], v[112:115], v[136:151]
    v_mfma_f32_32x32x16_bf16 v[152:167], v[28:31], v[112:115], v[152:167]
    s_waitcnt lgkmcnt(0)
    v_mfma_f32_32x32x16_bf16 v[136:151], v[32:35], v[116:119], v[136:151]
    v_mfma_f32_32x32x16_bf16 v[152:167], v[36:39], v[116:119], v[152:167]
    s_cmp_gt_u32 s4, 3
    s_cbranch_scc1 w4_10075
    s_waitcnt vmcnt(24)
    s_branch wj_10076
w4_10075:
    s_waitcnt vmcnt(16)
wj_10076:
    s_barrier
    s_cmp_gt_u32 s4, 3
    s_cbranch_scc1 nodma_10077
    s_add_u32 m0, s20, 32768
    s_add_u32 s21, s22, 1835008
    buffer_load_dwordx4 v1, s[12:15], s21 offen lds
    s_add_u32 s21, s21, 7168
    buffer_load_dwordx4 v1, s[12:15], s21 offen offset:1024 lds
nodma_10077:
    s_mov_b32 s21, 114688
    buffer_load_dwordx4 v[104:107], v2, s[8:11], s21 offen offset:0
    buffer_load_dwordx4 v[108:111], v2, s[8:11], s21 offen offset:1024
    buffer_load_dwordx4 v[112:115], v2, s[8:11], s21 offen offset:2048
    buffer_load_dwordx4 v[116:119], v2, s[8:11], s21 offen offset:3072
    ds_read_b64_tr_b16 v[8:9], v3 offset:40960
    ds_read_b64_tr_b16 v[10:11], v3 offset:41472
    ds_read_b64_tr_b16 v[12:13], v4 offset:40960
    ds_read_b64_tr_b16 v[14:15], v4 offset:41472
    ds_read_b64_tr_b16 v[16:17], v3 offset:41984
    ds_read_b64_tr_b16 v[18:19], v3 offset:42496
    ds_read_b64_tr_b16 v[20:21], v4 offset:41984
    ds_read_b64_tr_b16 v[22:23], v4 offset:42496
    ds_read_b64_tr_b16 v[24:25], v3 offset:43008
    ds_read_b64_tr_b16 v[26:27], v3 offset:43520
    ds_read_b64_tr_b16 v[28:29], v4 offset:43008
    ds_read_b64_tr_b16 v[30:31], v4 offset:43520
    ds_read_b64_tr_b16 v[32:33], v3 offset:44032
    ds_read_b64_tr_b16 v[34:35], v3 offset:44544
    ds_read_b64_tr_b16 v[36:37], v4 offset:44032
    ds_read_b64_tr_b16 v[38:39], v4 offset:44544
    s_waitcnt lgkmcnt(12)
    v_mfma_f32_32x32x16_bf16 v[136:151], v[8:11], v[120:123], v[136:151]
    v_mfma_f32_32x32x16_bf16 v[152:167], v[12:15], v[120:123], v[152:167]
    s_waitcnt lgkmcnt(8)
    v_mfma_f32_32x32x16_bf16 v[136:151], v[16:19], v[124:127], v[136:151]
    v_mfma_f32_32x32x16_bf16 v[152:167], v[20:23], v[124:127], v[152:167]
    s_waitcnt lgkmcnt(4)
    v_mfma_f32_32x32x16_bf16 v[136:151], v[24:27], v[128:131], v[136:151]
    v_mfma_f32_32x32x16_bf16 v[152:167], v[28:31], v[128:131], v[152:167]
    s_waitcnt lgkmcnt(0)
    v_mfma_f32_32x32x16_bf16 v[136:151], v[32:35], v[132:135], v[136:151]
    v_mfma_f32_32x32x16_bf16 v[152:167], v[36:39], v[132:135], v[152:167]
    s_cmp_gt_u32 s4, 3
    s_cbranch_scc1 w4_10078
    s_waitcnt vmcnt(24)
    s_branch wj_10079
w4_10078:
    s_waitcnt vmcnt(16)
wj_10079:
    s_barrier
    s_cmp_gt_u32 s4, 3
    s_cbranch_scc1 nodma_10080
    s_add_u32 m0, s20, 40960
    s_add_u32 s21, s22, 1900544
    buffer_load_dwordx4 v1, s[12:15], s21 offen lds
    s_add_u32 s21, s21, 7168
    buffer_load_dwordx4 v1, s[12:15], s21 offen offset:1024 lds
nodma_10080:
    s_mov_b32 s21, 118784
    buffer_load_dwordx4 v[120:123], v2, s[8:11], s21 offen offset:0
    buffer_load_dwordx4 v[124:127], v2, s[8:11], s21 offen offset:1024
    buffer_load_dwordx4 v[128:131], v2, s[8:11], s21 offen offset:2048
    buffer_load_dwordx4 v[132:135], v2, s[8:11], s21 offen offset:3072
    ds_read_b64_tr_b16 v[8:9], v3 offset:0
    ds_read_b64_tr_b16 v[10:11], v3 offset:512
    ds_read_b64_tr_b16 v[12:13], v4 offset:0
    ds_read_b64_tr_b16 v[14:15], v4 offset:512
    ds_read_b64_tr_b16 v[16:17], v3 offset:1024
    ds_read_b64_tr_b16 v[18:19], v3 offset:1536
    ds_read_b64_tr_b16 v[20:21], v4 offset:1024
    ds_read_b64_tr_b16 v[22:23], v4 offset:1536
    ds_read_b64_tr_b16 v[24:25], v3 offset:2048
    ds_read_b64_tr_b16 v[26:27], v3 offset:2560
    ds_read_b64_tr_b16 v[28:29], v4 offset:2048
    ds_read_b64_tr_b16 v[30:31], v4 offset:2560
    ds_read_b64_tr_b16 v[32:33], v3 offset:3072
    ds_read_b64_tr_b16 v[34:35], v3 offset:3584
    ds_read_b64_tr_b16 v[36:37], v4 offset:3072
    ds_read_b64_tr_b16 v[38:39], v4 offset:3584
    s_waitcnt lgkmcnt(12)
    v_mfma_f32_32x32x16_bf16 v[136:151], v[8:11], v[40:43], v[136:151]
    v_mfma_f32_32x32x16_bf16 v[152:167], v[12:15], v[40:43], v[152:167]
    s_waitcnt lgkmcnt(8)
    v_mfma_f32_32x32x16_bf16 v[136:151], v[16:19], v[44:47], v[136:151]
    v_mfma_f32_32x32x16_bf16 v[152:167], v[20:23], v[44:47], v[152:167]
    s_waitcnt lgkmcnt(4)
    v_mfma_f32_32x32x16_bf16 v[136:151], v[24:27], v[48:51], v[136:151]
    v_mfma_f32_32x32x16_bf16 v[152:167], v[28:31], v[48:51], v[152:167]
    s_waitcnt lgkmcnt(0)
    v_mfma_f32_32x32x16_bf16 v[136:151], v[32:35], v[52:55], v[136:151]
    v_mfma_f32_32x32x16_bf16 v[152:167], v[36:39], v[52:55], v[152:167]
    s_cmp_gt_u32 s4, 3
    s_cbranch_scc1 w4_10081
    s_waitcnt vmcnt(24)
    s_branch wj_10082
w4_10081:
    s_waitcnt vmcnt(16)
wj_10082:
    s_barrier
    s_cmp_gt_u32 s4, 3
    s_cbranch_scc1 nodma_10083
    s_add_u32 m0, s20, 0
    s_add_u32 s21, s22, 1966080
    buffer_load_dwordx4 v1, s[12:15], s21 offen lds
    s_add_u32 s21, s21, 7168
    buffer_load_dwordx4 v1, s[12:15], s21 offen offset:1024 lds
nodma_10083:
    s_mov_b32 s21, 122880
    buffer_load_dwordx4 v[40:43], v2, s[8:11], s21 offen offset:0
    buffer_load_dwordx4 v[44:47], v2, s[8:11], s21 offen offset:1024
    buffer_load_dwordx4 v[48:51], v2, s[8:11], s21 offen offset:2048
    buffer_load_dwordx4 v[52:55], v2, s[8:11], s21 offen offset:3072
    ds_read_b64_tr_b16 v[8:9], v3 offset:8192
    ds_read_b64_tr_b16 v[10:11], v3 offset:8704
    ds_read_b64_tr_b16 v[12:13], v4 offset:8192
    ds_read_b64_tr_b16 v[14:15], v4 offset:8704
    ds_read_b64_tr_b16 v[16:17], v3 offset:9216
    ds_read_b64_tr_b16 v[18:19], v3 offset:9728
    ds_read_b64_tr_b16 v[20:21], v4 offset:9216
    ds_read_b64_tr_b16 v[22:23], v4 offset:9728
    ds_read_b64_tr_b16 v[24:25], v3 offset:10240
    ds_read_b64_tr_b16 v[26:27], v3 offset:10752
    ds_read_b64_tr_b16 v[28:29], v4 offset:10240
    ds_read_b64_tr_b16 v[30:31], v4 offset:10752
    ds_read_b64_tr_b16 v[32:33], v3 offset:11264
    ds_read_b64_tr_b16 v[34:35], v3 offset:11776
    ds_read_b64_tr_b16 v[36:37], v4 offset:11264
    ds_read_b64_tr_b16 v[38:39], v4 offset:11776
    s_waitcnt lgkmcnt(12)
    v_mfma_f32_32x32x16_bf16 v[136:151], v[8:11], v[56:59], v[136:151]
    v_mfma_f32_32x32x16_bf16 v[152:167], v[12:15], v[56:59], v[152:167]
    s_waitcnt lgkmcnt(8)
    v_mfma_f32_32x32x16_bf16 v[136:151], v[16:19], v[60:63], v[136:151]
    v_mfma_f32_32x32x16_bf16 v[152:167], v[20:23], v[60:63], v[152:167]
    s_waitcnt lgkmcnt(4)
    v_mfma_f32_32x32x16_bf16 v[136:151], v[24:27], v[64:67], v[136:151]
    v_mfma_f32_32x32x16_bf16 v[152:167], v[28:31], v[64:67], v[152:167]
    s_waitcnt lgkmcnt(0)
    v_mfma_f32_32x32x16_bf16 v[136:151], v[32:35], v[68:71], v[136:151]
    v_mfma_f32_32x32x16_bf16 v[152:167], v[36:39], v[68:71], v[152:167]
    s_cmp_gt_u32 s4, 3
    s_cbranch_scc1 w4_10084
    s_waitcnt vmcnt(24)
    s_branch wj_10085
w4_10084:
    s_waitcnt vmcnt(16)
wj_10085:
    s_barrier
    s_cmp_gt_u32 s4, 3
    s_cbranch_scc1 nodma_10086
    s_add_u32 m0, s20, 8192
    s_add_u32 s21, s22, 2031616
    buffer_load_dwordx4 v1, s[12:15], s21 offen lds
    s_add_u32 s21, s21, 7168
    buffer_load_dwordx4 v1, s[12:15], s21 offen offset:1024 lds
nodma_10086:
    s_mov_b32 s21, 126976
    buffer_load_dwordx4 v[56:59], v2, s[8:11], s21 offen offset:0
    buffer_load_dwordx4 v[60:63], v2, s[8:11], s21 offen offset:1024
    buffer_load_dwordx4 v[64:67], v2, s[8:11], s21 offen offset:2048
    buffer_load_dwordx4 v[68:71], v2, s[8:11], s21 offen offset:3072
    ds_read_b64_tr_b16 v[8:9], v3 offset:16384
    ds_read_b64_tr_b16 v[10:11], v3 offset:16896
    ds_read_b64_tr_b16 v[12:13], v4 offset:16384
    ds_read_b64_tr_b16 v[14:15], v4 offset:16896
    ds_read_b64_tr_b16 v[16:17], v3 offset:17408
    ds_read_b64_tr_b16 v[18:19], v3 offset:17920
    ds_read_b64_tr_b16 v[20:21], v4 offset:17408
    ds_read_b64_tr_b16 v[22:23], v4 offset:17920
    ds_read_b64_tr_b16 v[24:25], v3 offset:18432
    ds_read_b64_tr_b16 v[26:27], v3 offset:18944
    ds_read_b64_tr_b16 v[28:29], v4 offset:18432
    ds_read_b64_tr_b16 v[30:31], v4 offset:18944
    ds_read_b64_tr_b16 v[32:33], v3 offset:19456
    ds_read_b64_tr_b16 v[34:35], v3 offset:19968
    ds_read_b64_tr_b16 v[36:37], v4 offset:19456
    ds_read_b64_tr_b16 v[38:39], v4 offset:19968
    s_waitcnt lgkmcnt(12)
    v_mfma_f32_32x32x16_bf16 v[136:151], v[8:11], v[72:75], v[136:151]
    v_mfma_f32_32x32x16_bf16 v[152:167], v[12:15], v[72:75], v[152:167]
    s_waitcnt lgkmcnt(8)
    v_mfma_f32_32x32x16_bf16 v[136:151], v[16:19], v[76:79], v[136:151]
    v_mfma_f32_32x32x16_bf16 v[152:167], v[20:23], v[76:79], v[152:167]
    s_waitcnt lgkmcnt(4)
    v_mfma_f32_32x32x16_bf16 v[136:151], v[24:27], v[80:83], v[136:151]
    v_mfma_f32_32x32x16_bf16 v[152:167], v[28:31], v[80:83], v[152:167]
    s_waitcnt lgkmcnt(0)
    v_mfma_f32_32x32x16_bf16 v[136:151], v[32:35], v[84:87], v[136:151]
    v_mfma_f32_32x32x16_bf16 v[152:167], v[36:39], v[84:87], v[152:167]
    s_cmp_gt_u32 s4, 3
    s_cbranch_scc1 w4_10087
    s_waitcnt vmcnt(24)
    s_branch wj_10088
w4_10087:
    s_waitcnt vmcnt(16)
wj_10088:
    s_barrier
    ds_read_b64_tr_b16 v[8:9], v3 offset:24576
    ds_read_b64_tr_b16 v[10:11], v3 offset:25088
    ds_read_b64_tr_b16 v[12:13], v4 offset:24576
    ds_read_b64_tr_b16 v[14:15], v4 offset:25088
    ds_read_b64_tr_b16 v[16:17], v3 offset:25600
    ds_read_b64_tr_b16 v[18:19], v3 offset:26112
    ds_read_b64_tr_b16 v[20:21], v4 offset:25600
    ds_read_b64_tr_b16 v[22:23], v4 offset:26112
    ds_read_b64_tr_b16 v[24:25], v3 offset:26624
    ds_read_b64_tr_b16 v[26:27], v3 offset:27136
    ds_read_b64_tr_b16 v[28:29], v4 offset:26624
    ds_read_b64_tr_b16 v[30:31], v4 offset:27136
    ds_read_b64_tr_b16 v[32:33], v3 offset:27648
    ds_read_b64_tr_b16 v[34:35], v3 offset:28160
    ds_read_b64_tr_b16 v[36:37], v4 offset:27648
    ds_read_b64_tr_b16 v[38:39], v4 offset:28160
    s_waitcnt lgkmcnt(12)
    v_mfma_f32_32x32x16_bf16 v[136:151], v[8:11], v[88:91], v[136:151]
    v_mfma_f32_32x32x16_bf16 v[152:167], v[12:15], v[88:91], v[152:167]
    s_waitcnt lgkmcnt(8)
    v_mfma_f32_32x32x16_bf16 v[136:151], v[16:19], v[92:95], v[136:151]
    v_mfma_f32_32x32x16_bf16 v[152:167], v[20:23], v[92:95], v[152:167]
    s_waitcnt lgkmcnt(4)
    v_mfma_f32_32x32x16_bf16 v[136:151], v[24:27], v[96:99], v[136:151]
    v_mfma_f32_32x32x16_bf16 v[152:167], v[28:31], v[96:99], v[152:167]
    s_waitcnt lgkmcnt(0)
    v_mfma_f32_32x32x16_bf16 v[136:151], v[32:35], v[100:103], v[136:151]
    v_mfma_f32_32x32x16_bf16 v[152:167], v[36:39], v[100:103], v[152:167]
    s_cmp_gt_u32 s4, 3
    s_cbranch_scc1 w4_10089
    s_waitcnt vmcnt(18)
    s_branch wj_10090
w4_10089:
    s_waitcnt vmcnt(12)
wj_10090:
    s_barrier
    ds_read_b64_tr_b16 v[8:9], v3 offset:32768
    ds_read_b64_tr_b16 v[10:11], v3 offset:33280
    ds_read_b64_tr_b16 v[12:13], v4 offset:32768
    ds_read_b64_tr_b16 v[14:15], v4 offset:33280
    ds_read_b64_tr_b16 v[16:17], v3 offset:33792
    ds_read_b64_tr_b16 v[18:19], v3 offset:34304
    ds_read_b64_tr_b16 v[20:21], v4 offset:33792
    ds_read_b64_tr_b16 v[22:23], v4 offset:34304
    ds_read_b64_tr_b16 v[24:25], v3 offset:34816
    ds_read_b64_tr_b16 v[26:27], v3 offset:35328
    ds_read_b64_tr_b16 v[28:29], v4 offset:34816
    ds_read_b64_tr_b16 v[30:31], v4 offset:35328
    ds_read_b64_tr_b16 v[32:33], v3 offset:35840
    ds_read_b64_tr_b16 v[34:35], v3 offset:36352
    ds_read_b64_tr_b16 v[36:37], v4 offset:35840
    ds_read_b64_tr_b16 v[38:39], v4 offset:36352
    s_waitcnt lgkmcnt(12)
    v_mfma_f32_32x32x16_bf16 v[136:151], v[8:11], v[104:107], v[136:151]
    v_mfma_f32_32x32x16_bf16 v[152:167], v[12:15], v[104:107], v[152:167]
    s_waitcnt lgkmcnt(8)
    v_mfma_f32_32x32x16_bf16 v[136:151], v[16:19], v[108:111], v[136:151]
    v_mfma_f32_32x32x16_bf16 v[152:167], v[20:23], v[108:111], v[152:167]
    s_waitcnt lgkmcnt(4)
    v_mfma_f32_32x32x16_bf16 v[136:151], v[24:27], v[112:115], v[136:151]
    v_mfma_f32_32x32x16_bf16 v[152:167], v[28:31], v[112:115], v[152:167]
    s_waitcnt lgkmcnt(0)
    v_mfma_f32_32x32x16_bf16 v[136:151], v[32:35], v[116:119], v[136:151]
    v_mfma_f32_32x32x16_bf16 v[152:167], v[36:39], v[116:119], v[152:167]
    s_cmp_gt_u32 s4, 3
    s_cbranch_scc1 w4_10091
    s_waitcnt vmcnt(12)
    s_branch wj_10092
w4_10091:
    s_waitcnt vmcnt(8)
wj_10092:
    s_barrier
    ds_read_b64_tr_b16 v[8:9], v3 offset:40960
    ds_read_b64_tr_b16 v[10:11], v3 offset:41472
    ds_read_b64_tr_b16 v[12:13], v4 offset:40960
    ds_read_b64_tr_b16 v[14:15], v4 offset:41472
    ds_read_b64_tr_b16 v[16:17], v3 offset:41984
    ds_read_b64_tr_b16 v[18:19], v3 offset:42496
    ds_read_b64_tr_b16 v[20:21], v4 offset:41984
    ds_read_b64_tr_b16 v[22:23], v4 offset:42496
    ds_read_b64_tr_b16 v[24:25], v3 offset:43008
    ds_read_b64_tr_b16 v[26:27], v3 offset:43520
    ds_read_b64_tr_b16 v[28:29], v4 offset:43008
    ds_read_b64_tr_b16 v[30:31], v4 offset:43520
    ds_read_b64_tr_b16 v[32:33], v3 offset:44032
    ds_read_b64_tr_b16 v[34:35], v3 offset:44544
    ds_read_b64_tr_b16 v[36:37], v4 offset:44032
    ds_read_b64_tr_b16 v[38:39], v4 offset:44544
    s_waitcnt lgkmcnt(12)
    v_mfma_f32_32x32x16_bf16 v[136:151], v[8:11], v[120:123], v[136:151]
    v_mfma_f32_32x32x16_bf16 v[152:167], v[12:15], v[120:123], v[152:167]
    s_waitcnt lgkmcnt(8)
    v_mfma_f32_32x32x16_bf16 v[136:151], v[16:19], v[124:127], v[136:151]
    v_mfma_f32_32x32x16_bf16 v[152:167], v[20:23], v[124:127], v[152:167]
    s_waitcnt lgkmcnt(4)
    v_mfma_f32_32x32x16_bf16 v[136:151], v[24:27], v[128:131], v[136:151]
    v_mfma_f32_32x32x16_bf16 v[152:167], v[28:31], v[128:131], v[152:167]
    s_waitcnt lgkmcnt(0)
    v_mfma_f32_32x32x16_bf16 v[136:151], v[32:35], v[132:135], v[136:151]
    v_mfma_f32_32x32x16_bf16 v[152:167], v[36:39], v[132:135], v[152:167]
    s_cmp_gt_u32 s4, 3
    s_cbranch_scc1 w4_10093
    s_waitcnt vmcnt(6)
    s_branch wj_10094
w4_10093:
    s_waitcnt vmcnt(4)
wj_10094:
    s_barrier
    ds_read_b64_tr_b16 v[8:9], v3 offset:0
    ds_read_b64_tr_b16 v[10:11], v3 offset:512
    ds_read_b64_tr_b16 v[12:13], v4 offset:0
    ds_read_b64_tr_b16 v[14:15], v4 offset:512
    ds_read_b64_tr_b16 v[16:17], v3 offset:1024
    ds_read_b64_tr_b16 v[18:19], v3 offset:1536
    ds_read_b64_tr_b16 v[20:21], v4 offset:1024
    ds_read_b64_tr_b16 v[22:23], v4 offset:1536
    ds_read_b64_tr_b16 v[24:25], v3 offset:2048
    ds_read_b64_tr_b16 v[26:27], v3 offset:2560
    ds_read_b64_tr_b16 v[28:29], v4 offset:2048
    ds_read_b64_tr_b16 v[30:31], v4 offset:2560
    ds_read_b64_tr_b16 v[32:33], v3 offset:3072
    ds_read_b64_tr_b16 v[34:35], v3 offset:3584
    ds_read_b64_tr_b16 v[36:37], v4 offset:3072
    ds_read_b64_tr_b16 v[38:39], v4 offset:3584
    s_waitcnt lgkmcnt(12)
    v_mfma_f32_32x32x16_bf16 v[136:151], v[8:11], v[40:43], v[136:151]
    v_mfma_f32_32x32x16_bf16 v[152:167], v[12:15], v[40:43], v[152:167]
    s_waitcnt lgkmcnt(8)
    v_mfma_f32_32x32x16_bf16 v[136:151], v[16:19], v[44:47], v[136:151]
    v_mfma_f32_32x32x16_bf16 v[152:167], v[20:23], v[44:47], v[152:167]
    s_waitcnt lgkmcnt(4)
    v_mfma_f32_32x32x16_bf16 v[136:151], v[24:27], v[48:51], v[136:151]
    v_mfma_f32_32x32x16_bf16 v[152:167], v[28:31], v[48:51], v[152:167]
    s_waitcnt lgkmcnt(0)
    v_mfma_f32_32x32x16_bf16 v[136:151], v[32:35], v[52:55], v[136:151]
    v_mfma_f32_32x32x16_bf16 v[152:167], v[36:39], v[52:55], v[152:167]
    s_waitcnt vmcnt(0)
    s_barrier
    ds_read_b64_tr_b16 v[8:9], v3 offset:8192
    ds_read_b64_tr_b16 v[10:11], v3 offset:8704
    ds_read_b64_tr_b16 v[12:13], v4 offset:8192
    ds_read_b64_tr_b16 v[14:15], v4 offset:8704
    ds_read_b64_tr_b16 v[16:17], v3 offset:9216
    ds_read_b64_tr_b16 v[18:19], v3 offset:9728
    ds_read_b64_tr_b16 v[20:21], v4 offset:9216
    ds_read_b64_tr_b16 v[22:23], v4 offset:9728
    ds_read_b64_tr_b16 v[24:25], v3 offset:10240
    ds_read_b64_tr_b16 v[26:27], v3 offset:10752
    ds_read_b64_tr_b16 v[28:29], v4 offset:10240
    ds_read_b64_tr_b16 v[30:31], v4 offset:10752
    ds_read_b64_tr_b16 v[32:33], v3 offset:11264
    ds_read_b64_tr_b16 v[34:35], v3 offset:11776
    ds_read_b64_tr_b16 v[36:37], v4 offset:11264
    ds_read_b64_tr_b16 v[38:39], v4 offset:11776
    s_waitcnt lgkmcnt(12)
    v_mfma_f32_32x32x16_bf16 v[136:151], v[8:11], v[56:59], v[136:151]
    v_mfma_f32_32x32x16_bf16 v[152:167], v[12:15], v[56:59], v[152:167]
    s_waitcnt lgkmcnt(8)
    v_mfma_f32_32x32x16_bf16 v[136:151], v[16:19], v[60:63], v[136:151]
    v_mfma_f32_32x32x16_bf16 v[152:167], v[20:23], v[60:63], v[152:167]
    s_waitcnt lgkmcnt(4)
    v_mfma_f32_32x32x16_bf16 v[136:151], v[24:27], v[64:67], v[136:151]
    v_mfma_f32_32x32x16_bf16 v[152:167], v[28:31], v[64:67], v[152:167]
    s_waitcnt lgkmcnt(0)
    v_mfma_f32_32x32x16_bf16 v[136:151], v[32:35], v[68:71], v[136:151]
    v_mfma_f32_32x32x16_bf16 v[152:167], v[36:39], v[68:71], v[152:167]
    s_nop 15
    s_barrier
    s_cmp_eq_u32 s23, 0
    s_cbranch_scc1 op_g0
    ds_write_b128 v6, v[136:139] offset:0
    ds_write_b128 v6, v[140:143] offset:1024
    ds_write_b128 v6, v[144:147] offset:2048
    ds_write_b128 v6, v[148:151] offset:3072
    ds_write_b128 v6, v[152:155] offset:4096
    ds_write_b128 v6, v[156:159] offset:5120
    ds_write_b128 v6, v[160:163] offset:6144
    ds_write_b128 v6, v[164:167] offset:7168
    s_waitcnt lgkmcnt(0)
    s_barrier
    s_endpgm
op_g0:
    s_barrier
    ds_read_b128 v[40:43], v6 offset:0
    ds_read_b128 v[44:47], v6 offset:1024
    ds_read_b128 v[48:51], v6 offset:2048
    ds_read_b128 v[52:55], v6 offset:3072
    ds_read_b128 v[56:59], v6 offset:4096
    ds_read_b128 v[60:63], v6 offset:5120
    ds_read_b128 v[64:67], v6 offset:6144
    ds_read_b128 v[68:71], v6 offset:7168
    s_waitcnt lgkmcnt(0)
    v_add_f32 v136, v136, v40
    v_add_f32 v137, v137, v41
    v_add_f32 v138, v138, v42
    v_add_f32 v139, v139, v43
    v_add_f32 v140, v140, v44
    v_add_f32 v141, v141, v45
    v_add_f32 v142, v142, v46
    v_add_f32 v143, v143, v47
    v_add_f32 v144, v144, v48
    v_add_f32 v145, v145, v49
    v_add_f32 v146, v146, v50
    v_add_f32 v147, v147, v51
    v_add_f32 v148, v148, v52
    v_add_f32 v149, v149, v53
    v_add_f32 v150, v150, v54
    v_add_f32 v151, v151, v55
    v_add_f32 v152, v152, v56
    v_add_f32 v153, v153, v57
    v_add_f32 v154, v154, v58
    v_add_f32 v155, v155, v59
    v_add_f32 v156, v156, v60
    v_add_f32 v157, v157, v61
    v_add_f32 v158, v158, v62
    v_add_f32 v159, v159, v63
    v_add_f32 v160, v160, v64
    v_add_f32 v161, v161, v65
    v_add_f32 v162, v162, v66
    v_add_f32 v163, v163, v67
    v_add_f32 v164, v164, v68
    v_add_f32 v165, v165, v69
    v_add_f32 v166, v166, v70
    v_add_f32 v167, v167, v71
    v_cvt_pk_bf16_f32 v136, v136, v137
    v_cvt_pk_bf16_f32 v137, v138, v139
    v_cvt_pk_bf16_f32 v138, v140, v141
    v_cvt_pk_bf16_f32 v139, v142, v143
    v_cvt_pk_bf16_f32 v140, v144, v145
    v_cvt_pk_bf16_f32 v141, v146, v147
    v_cvt_pk_bf16_f32 v142, v148, v149
    v_cvt_pk_bf16_f32 v143, v150, v151
    v_cvt_pk_bf16_f32 v144, v152, v153
    v_cvt_pk_bf16_f32 v145, v154, v155
    v_cvt_pk_bf16_f32 v146, v156, v157
    v_cvt_pk_bf16_f32 v147, v158, v159
    v_cvt_pk_bf16_f32 v148, v160, v161
    v_cvt_pk_bf16_f32 v149, v162, v163
    v_cvt_pk_bf16_f32 v150, v164, v165
    v_cvt_pk_bf16_f32 v151, v166, v167
    buffer_store_dwordx4 v[136:139], v5, s[16:19], 0 offen offset:0
    buffer_store_dwordx4 v[140:143], v5, s[16:19], 0 offen offset:16
    buffer_store_dwordx4 v[144:147], v5, s[16:19], 0 offen offset:32
    buffer_store_dwordx4 v[148:151], v5, s[16:19], 0 offen offset:48
oproj_end:
    s_endpgm
.globl repack_kernel
.p2align 8
.type repack_kernel,@function
repack_kernel:
    s_cmp_ge_u32 s2, 160
    s_cbranch_scc1 repack_end
    s_load_dwordx2 s[8:9], s[0:1], 0
    s_load_dwordx2 s[10:11], s[0:1], 40
    s_load_dwordx2 s[12:13], s[0:1], 96
    v_lshrrev_b32 v1, 6, v0
    v_and_b32 v0, 63, v0
    s_nop 0
    v_readfirstlane_b32 s4, v1
    s_cmp_ge_u32 s2, 80
    s_cselect_b32 s3, 1, 0
    s_mul_i32 s5, s3, 80
    s_sub_u32 s5, s2, s5
    s_waitcnt lgkmcnt(0)
    s_cmp_eq_u32 s3, 0
    s_cselect_b64 s[8:9], s[8:9], s[10:11]
    s_lshl_b32 s6, s5, 15
    s_add_u32 s16, s8, s6
    s_addc_u32 s17, s9, 0
    s_mov_b32 s18, 32768
    s_mov_b32 s19, 0x00020000
    s_lshl_b32 s6, s2, 15
    s_add_u32 s6, s6, 41943040
    s_add_u32 s20, s12, s6
    s_addc_u32 s21, s13, 0
    s_mov_b32 s22, 32768
    s_mov_b32 s23, 0x00020000
    v_and_b32 v2, 31, v0
    v_lshrrev_b32 v3, 5, v0
    v_lshlrev_b32 v4, 6, v3
    v_lshl_add_u32 v4, v2, 10, v4
    s_lshl_b32 s7, s4, 8
    v_add_u32 v4, s7, v4
    v_lshlrev_b32 v5, 4, v0
    s_lshl_b32 s7, s4, 13
    v_add_u32 v5, s7, v5
    buffer_load_dwordx4 v[8:11], v4, s[16:19], 0 offen offset:0
    buffer_load_dwordx4 v[12:15], v4, s[16:19], 0 offen offset:16
    buffer_load_dwordx4 v[16:19], v4, s[16:19], 0 offen offset:32
    buffer_load_dwordx4 v[20:23], v4, s[16:19], 0 offen offset:48
    buffer_load_dwordx4 v[24:27], v4, s[16:19], 0 offen offset:128
    buffer_load_dwordx4 v[28:31], v4, s[16:19], 0 offen offset:144
    buffer_load_dwordx4 v[32:35], v4, s[16:19], 0 offen offset:160
    buffer_load_dwordx4 v[36:39], v4, s[16:19], 0 offen offset:176
    s_waitcnt vmcnt(7)
    s_waitcnt vmcnt(0)
    buffer_store_dwordx4 v[8:11], v5, s[20:23], 0 offen offset:0
    buffer_store_dwordx4 v[12:15], v5, s[20:23], 0 offen offset:1024
    buffer_store_dwordx4 v[16:19], v5, s[20:23], 0 offen offset:2048
    buffer_store_dwordx4 v[20:23], v5, s[20:23], 0 offen offset:3072
    v_add_u32 v5, 4096, v5
    buffer_store_dwordx4 v[24:27], v5, s[20:23], 0 offen offset:0
    buffer_store_dwordx4 v[28:31], v5, s[20:23], 0 offen offset:1024
    buffer_store_dwordx4 v[32:35], v5, s[20:23], 0 offen offset:2048
    buffer_store_dwordx4 v[36:39], v5, s[20:23], 0 offen offset:3072
repack_end:
    s_endpgm
.section .rodata,"a"
.p2align 6
.amdhsa_kernel repack_kernel
  .amdhsa_next_free_vgpr 48
  .amdhsa_next_free_sgpr 96
  .amdhsa_accum_offset 48
  .amdhsa_group_segment_fixed_size 0
  .amdhsa_kernarg_size 104
  .amdhsa_user_sgpr_count 2
  .amdhsa_user_sgpr_kernarg_segment_ptr 1
  .amdhsa_system_sgpr_workgroup_id_x 1
.end_amdhsa_kernel
.section .rodata,"a"
.p2align 6
.amdhsa_kernel attn_kernel
  .amdhsa_next_free_vgpr 168
  .amdhsa_next_free_sgpr 96
  .amdhsa_accum_offset 168
  .amdhsa_group_segment_fixed_size 0
  .amdhsa_kernarg_size 104
  .amdhsa_user_sgpr_count 2
  .amdhsa_user_sgpr_kernarg_segment_ptr 1
  .amdhsa_system_sgpr_workgroup_id_x 1
.end_amdhsa_kernel
.section .rodata,"a"
.p2align 6
.amdhsa_kernel oproj_kernel
  .amdhsa_next_free_vgpr 168
  .amdhsa_next_free_sgpr 96
  .amdhsa_accum_offset 168
  .amdhsa_group_segment_fixed_size 0
  .amdhsa_kernarg_size 104
  .amdhsa_user_sgpr_count 2
  .amdhsa_user_sgpr_kernarg_segment_ptr 1
  .amdhsa_system_sgpr_workgroup_id_x 1
.end_amdhsa_kernel
```
